```python
import torch

def _softmax(x, axis=-1):
    return torch.softmax(x, dim=axis)
def _gelu(x):
    return torch.nn.functional.gelu(x, approximate="tanh")
def _silu(x):
    return torch.nn.functional.silu(x)
def _sigmoid(x):
    return torch.sigmoid(x)
def _layernorm(x, axis=-1, eps=1e-5):
    m = x.mean(dim=axis, keepdim=True)
    v = x.var(dim=axis, keepdim=True, unbiased=False)
    return (x - m) / torch.sqrt(v + eps)
def _scatter_add(tgt, idx, src, axis=0):
    return tgt.clone().index_add_(axis, idx, src)
def _segment_sum(src, seg, n):
    out = torch.zeros((n,) + src.shape[1:], dtype=src.dtype)
    return out.index_add_(0, seg, src)
def _pad(x, pw):
    flat = tuple(v for pair in reversed(pw) for v in pair)
    return torch.nn.functional.pad(x, flat)

kernel_name = 'sequential_preLN__grouped_kv_mqa__moe_arch_mod__prompt'

def setup_inputs():

    _w = (lambda a: (lambda t: t.to(torch.bfloat16) if t.is_floating_point() else t)(torch.as_tensor(a)))
    def _A_setup():
        B, S, D, H = 1, 2048, 448, 16
        Dh = D // H
        return {
            "x": _w((lambda *s: torch.randn(*s, dtype=torch.bfloat16) * 0.05)(B, S, D)),
            "wq": _w((lambda *s: torch.randn(*s, dtype=torch.bfloat16) * 0.05)(D, H * Dh)),
            "wk": _w((lambda *s: torch.randn(*s, dtype=torch.bfloat16) * 0.05)(D, Dh)),
            "wv": _w((lambda *s: torch.randn(*s, dtype=torch.bfloat16) * 0.05)(D, Dh)),
            "wo": _w((lambda *s: torch.randn(*s, dtype=torch.bfloat16) * 0.05)(H * Dh, D)),
        }
    _A_in = _A_setup()

    def _B_setup():
        B, S, D, F, C = 1, 2048, 448, 1792, 2
        return {
            "x": _w((lambda *s: torch.randn(*s, dtype=torch.bfloat16) * 0.05)(B, S, D)),
            "w_r": _w((lambda *s: torch.randn(*s, dtype=torch.bfloat16) * 0.05)(D)),
            "w_gate": _w((lambda *s: torch.randn(*s, dtype=torch.bfloat16) * 0.05)(D, F)),
            "w_up": _w((lambda *s: torch.randn(*s, dtype=torch.bfloat16) * 0.05)(D, F)),
            "w_down": _w((lambda *s: torch.randn(*s, dtype=torch.bfloat16) * 0.05)(F, D)),
        }
    _B_in = _B_setup()

    return {
        "A_x": _A_in["x"],
        "A_wq": _A_in["wq"],
        "A_wk": _A_in["wk"],
        "A_wv": _A_in["wv"],
        "A_wo": _A_in["wo"],
        "B_x": _B_in["x"],
        "B_w_r": _B_in["w_r"],
        "B_w_gate": _B_in["w_gate"],
        "B_w_up": _B_in["w_up"],
        "B_w_down": _B_in["w_down"],
    }

def reference(A_x, A_wq, A_wk, A_wv, A_wo, B_x, B_w_r, B_w_gate, B_w_up, B_w_down):
    def _A_ref(x, wq, wk, wv, wo):
        B, S, D = x.shape
        H = 16
        Dh = D // H
        q = (lambda x, *d: x.permute(*d))((x @ wq).reshape(B, S, H, Dh), 0, 2, 1, 3)
        k = x @ wk
        v = x @ wv
        scores = torch.einsum("bhqd,bkd->bhqk", q, k) * (Dh ** -0.5)
        p = _softmax(scores, axis=-1)
        o = torch.einsum("bhqk,bkd->bhqd", p, v)
        return (lambda x, *d: x.permute(*d))(o, 0, 2, 1, 3).reshape(B, S, H * Dh) @ wo

    def _B_ref(x, w_r, w_gate, w_up, w_down):
        B, S, D = x.shape
        C = 2
        r = x @ w_r
        idx = torch.argsort(-r, axis=-1)[:, :C]
        idx_e = (lambda x, n, axis: torch.repeat_interleave(x, n, dim=axis))(idx.reshape(B, C, 1), D, axis=2)
        x_sel = (lambda x, i, axis: torch.take_along_dim(x, i, dim=axis))(x, idx_e, axis=1)
        g = _silu(x_sel @ w_gate)
        u = x_sel @ w_up
        y = (g * u) @ w_down
        r_sel = _sigmoid((lambda x, i, axis: torch.take_along_dim(x, i, dim=axis))(r, idx, axis=1))
        y = y * r_sel.reshape(B, C, 1)
        b_off = (torch.arange(B) * S).reshape(B, 1)
        flat_idx = (idx + b_off).reshape(B * C)
        zero = (x * 0.0).reshape(B * S, D)
        upd = _scatter_add(zero, flat_idx, y.reshape(B * C, D), axis=0)
        return x + upd.reshape(B, S, D)

    x = A_x
    h = x + _A_ref(_layernorm(x, axis=-1), A_wq, A_wk, A_wv, A_wo)
    h2 = h + _B_ref(_layernorm(h, axis=-1), B_w_r, B_w_gate, B_w_up, B_w_down)
    return h2
```

```asm
; @launch kernel=k1_kernel grid=(256,1,1) block=(384,1,1) lds=121856
; @launch kernel=k2_kernel grid=(256,1,1) block=(256,1,1) lds=135760
.amdgcn_target "amdgcn-amd-amdhsa--gfx950"
.text
.p2align 12
.globl k1_kernel
.p2align 8
.type k1_kernel,@function
k1_kernel:
s_cmp_ge_u32 s2, 256
s_cbranch_scc1 L_k1_kernel_end
s_load_dwordx8 s[4:11], s[0:1], 0
s_load_dwordx2 s[12:13], s[0:1], 32
s_load_dwordx2 s[14:15], s[0:1], 96
v_lshrrev_b32 v2, 6, v0
v_and_b32 v1, 63, v0
v_readfirstlane_b32 s32, v2
s_and_b32 s33, s2, 31
s_lshr_b32 s34, s2, 5
s_cmp_lt_u32 s32, 4
s_cbranch_scc1 L_k1_kernel_main
s_mov_b32 s71, 6
s_bitcmp1_b32 s2, 3
s_cbranch_scc1 L_pf_t0_0
s_bitcmp1_b32 s2, 4
s_cbranch_scc1 L_pf_t1_0
s_bitcmp1_b32 s2, 5
s_cbranch_scc1 L_pf_t2_0
s_bitcmp1_b32 s32, 0
s_cbranch_scc1 L_pf_e1_0
s_branch L_pf_e0_0
L_pf_t2_0:
s_bitcmp1_b32 s32, 0
s_cbranch_scc1 L_pf_e1_4
s_branch L_pf_e0_4
L_pf_t1_0:
s_bitcmp1_b32 s2, 5
s_cbranch_scc1 L_pf_t2_2
s_bitcmp1_b32 s32, 0
s_cbranch_scc1 L_pf_e1_2
s_branch L_pf_e0_2
L_pf_t2_2:
s_bitcmp1_b32 s32, 0
s_cbranch_scc1 L_pf_e1_6
s_branch L_pf_e0_6
L_pf_t0_0:
s_bitcmp1_b32 s2, 4
s_cbranch_scc1 L_pf_t1_1
s_bitcmp1_b32 s2, 5
s_cbranch_scc1 L_pf_t2_1
s_bitcmp1_b32 s32, 0
s_cbranch_scc1 L_pf_e1_1
s_branch L_pf_e0_1
L_pf_t2_1:
s_bitcmp1_b32 s32, 0
s_cbranch_scc1 L_pf_e1_5
s_branch L_pf_e0_5
L_pf_t1_1:
s_bitcmp1_b32 s2, 5
s_cbranch_scc1 L_pf_t2_3
s_bitcmp1_b32 s32, 0
s_cbranch_scc1 L_pf_e1_3
s_branch L_pf_e0_3
L_pf_t2_3:
s_bitcmp1_b32 s32, 0
s_cbranch_scc1 L_pf_e1_7
s_branch L_pf_e0_7
L_pf_ret:
s_endpgm
L_k1_kernel_main:
v_lshrrev_b32 v2, 3, v1
v_mul_u32_u24 v3, 896, v2
v_lshrrev_b32 v4, 4, v1
v_and_b32 v5, 7, v1
v_xor_b32 v4, v4, v5
v_lshl_add_u32 v6, v4, 4, v3
v_xor_b32 v7, 64, v6
s_lshl_b32 s46, s33, 2
s_add_u32 s46, s46, s32
s_mul_i32 s37, s46, 14336
s_add_u32 s38, s37, 7168
s_lshl_b32 s43, s32, 11
s_add_u32 s41, s43, 57344
s_add_u32 s42, s43, 58368
s_lshr_b32 s53, s33, 3
s_lshl_b32 s53, s53, 1
s_add_u32 s53, s53, s34
s_cmp_ge_u32 s53, 7
s_cselect_b32 s46, 7, 0
s_sub_u32 s53, s53, s46
s_lshl_b32 s53, s53, 7
s_lshl_b32 s46, s34, 7
s_cmp_eq_u32 s34, 7
s_cselect_b32 s40, 28, 448
s_cselect_b32 s46, 0, s46
s_cselect_b32 s62, 0, 7168
s_cselect_b32 s58, 448, 64
s_mul_i32 s22, s40, 896
s_sub_u32 s62, s22, s62
s_lshl_b32 s44, s40, 1
s_mul_i32 s39, s32, s44
s_lshl_b32 s39, s39, 4
s_add_u32 s39, s39, s46
v_bfe_u32 v2, v1, 2, 3
v_mul_u32_u24 v3, s44, v2
v_lshrrev_b32 v4, 5, v1
v_mad_u32_u24 v3, v4, s58, v3
v_and_b32 v4, 2, v2
v_xor_b32 v4, v4, v1
v_and_b32 v4, 3, v4
v_lshl_add_u32 v8, v4, 4, v3
s_mov_b32 s18, 1835008
s_mov_b32 s19, 0x20000
s_mov_b32 s23, 0x20000
s_mov_b32 s63, 0x20000
s_add_u32 s54, s37, s53
s_mov_b32 m0, s41
s_waitcnt lgkmcnt(0)
s_mov_b32 s16, s4
s_mov_b32 s17, s5
s_mul_i32 s56, s53, s40
buffer_load_dwordx4 v6, s[16:19], s54 offen lds
s_add_u32 s55, s38, s53
s_add_u32 m0, s42, 0
s_add_u32 s56, s56, s39
buffer_load_dwordx4 v7, s[16:19], s55 offen lds
s_add_u32 s60, s6, 7168
s_addc_u32 s61, s7, 0
s_cmp_eq_u32 s34, 7
s_cselect_b32 s20, s8, s6
s_cselect_b32 s21, s9, s7
s_cselect_b32 s60, s10, s60
s_cselect_b32 s61, s11, s61
s_add_u32 m0, s43, 0
s_add_u32 s53, s53, 128
buffer_load_dwordx4 v8, s[20:23], s56 offen lds
s_add_u32 m0, s43, 1024
s_cmp_eq_u32 s53, 896
s_cselect_b32 s53, 0, s53
buffer_load_dwordx4 v8, s[60:63], s56 offen lds
s_add_u32 s54, s37, s53
s_add_u32 m0, s41, 8192
s_mul_i32 s56, s53, s40
buffer_load_dwordx4 v6, s[16:19], s54 offen lds
s_add_u32 s55, s38, s53
s_add_u32 m0, s42, 8192
s_add_u32 s56, s56, s39
buffer_load_dwordx4 v7, s[16:19], s55 offen lds
s_add_u32 m0, s43, 8192
s_add_u32 s53, s53, 128
buffer_load_dwordx4 v8, s[20:23], s56 offen lds
s_add_u32 m0, s43, 9216
s_cmp_eq_u32 s53, 896
s_cselect_b32 s53, 0, s53
buffer_load_dwordx4 v8, s[60:63], s56 offen lds
v_lshrrev_b32 v4, 2, v1
v_mul_u32_u24 v4, 896, v4
v_and_b32 v5, 3, v1
v_lshl_add_u32 v9, v5, 4, v4
s_mov_b32 s26, 401408
s_mov_b32 s27, 0x20000
s_and_b32 s35, s32, 1
s_lshr_b32 s36, s32, 1
s_mul_i32 s48, s2, 4682
s_lshr_b32 s48, s48, 16
s_mul_i32 s49, s48, 14
s_sub_u32 s49, s2, s49
s_lshl_b32 s50, s48, 1
s_add_u32 s50, s50, s35
s_mul_i32 s50, s50, 14336
s_lshl_b32 s46, s49, 6
s_add_u32 s50, s50, s46
s_cmp_lt_u32 s2, 196
s_cselect_b32 s52, 1, 0
s_cmp_lt_u32 s32, 2
s_cselect_b32 s52, s52, 0
s_lshl_b32 s46, s49, 1
s_add_u32 s46, s46, s35
s_mul_i32 s47, s46, 37
s_lshr_b32 s47, s47, 8
s_mul_i32 s51, s47, 91
s_add_u32 s51, s51, s46
s_mul_i32 s47, s48, 7
s_add_u32 s51, s51, s47
s_lshl_b32 s51, s51, 10
s_add_u32 s51, s51, 0x200000
s_mov_b32 s30, 0x400000
s_mov_b32 s31, 0x20000
v_and_b32 v2, 31, v1
s_lshl_b32 s46, s35, 12
s_add_u32 s46, s46, 57344
v_lshlrev_b32 v2, 7, v2
v_add_u32 v2, s46, v2
v_lshrrev_b32 v3, 5, v1
v_bfe_u32 v4, v1, 1, 3
v_xor_b32 v3, v3, v4
s_lshl_b32 s47, s32, 1
v_xor_b32 v3, s47, v3
v_lshl_add_u32 v10, v3, 4, v2
v_xor_b32 v11, 32, v10
v_xor_b32 v12, 64, v10
v_xor_b32 v13, 96, v10
v_lshrrev_b32 v3, 4, v1
v_xor_b32 v4, v4, v3
v_and_b32 v2, 15, v1
v_lshlrev_b32 v5, 7, v2
v_lshl_add_u32 v5, v4, 4, v5
v_add_u32 v18, s41, v5
v_xor_b32 v19, 64, v18
s_lshl_b32 s46, s32, 7
s_add_u32 s47, s46, 116736
v_lshl_add_u32 v22, v2, 3, s47
v_lshrrev_b32 v2, 5, v1
v_bfe_u32 v4, v1, 2, 2
s_cmp_eq_u32 s34, 7
s_cselect_b32 s59, 9, 10
v_lshlrev_b32 v5, s59, v2
v_lshl_add_u32 v5, v4, 6, v5
s_sub_u32 s59, 19, s59
v_lshrrev_b32 v21, 3, v1
v_xor_b32 v21, v21, v3
v_and_b32 v21, 1, v21
v_and_b32 v23, 3, v1
v_lshlrev_b32 v23, 3, v23
v_lshl_add_u32 v21, v21, 5, v23
s_lshl_b32 s47, s36, s59
s_add_u32 s47, s47, s43
v_add3_u32 v14, v5, v21, s47
v_xor_b32 v15, 2048, v14
v_xor_b32 v16, 4096, v14
v_xor_b32 v17, 6144, v14
v_lshl_add_u32 v5, v3, 3, v4
v_lshl_add_u32 v5, v5, 6, v23
s_lshl_b32 s47, s35, 5
s_add_u32 s47, s47, 114688
v_add_u32 v20, s47, v5
v_lshl_add_u32 v5, v2, 2, v4
v_lshl_add_u32 v26, v5, 6, v21
v_lshrrev_b32 v5, 2, v1
v_xor_b32 v5, v5, v3
v_and_b32 v5, 1, v5
v_add_u32 v5, -1, v5
v_mov_b32 v32, 0x3f803f80
v_mov_b32 v33, 0x3f803f80
v_mov_b32 v34, 0x3f803f80
v_mov_b32 v35, 0x3f803f80
v_and_b32 v28, v5, v32
v_and_b32 v29, v5, v32
v_and_b32 v30, v5, v32
v_and_b32 v31, v5, v32
v_and_b32 v5, 31, v1
s_add_u32 s46, s46, 117248
v_lshl_add_u32 v23, v5, 2, s46
s_lshl_b32 s46, s35, 8
s_add_u32 s46, s46, 116736
v_lshl_add_u32 v24, v5, 3, s46
s_lshl_b32 s46, s36, 8
s_add_u32 s46, s46, 117248
v_lshl_add_u32 v25, v2, 4, s46
v_lshrrev_b32 v21, 3, v5
v_mul_u32_u24 v21, 7040, v21
v_lshl_add_u32 v21, v5, 4, v21
v_lshl_add_u32 v21, v2, 7, v21
s_lshl_b32 s46, s33, 1
s_add_u32 s46, s46, s35
s_mul_i32 s57, s46, 28672
s_lshl_b32 s47, s34, 10
s_add_u32 s57, s57, s47
s_lshl_b32 s47, s36, 9
s_add_u32 s57, s57, s47
s_lshl_b32 s46, s46, 12
s_add_u32 s46, s46, 0x1c0000
s_cmp_eq_u32 s34, 7
s_cselect_b32 s57, s46, s57
s_cselect_b32 s45, 1.0, 0x3e8b97f6
s_mov_b32 s64, 0xaaaaaaaa
s_mov_b32 s65, 0xaaaaaaaa
s_mov_b32 s66, 0xcccccccc
s_mov_b32 s67, 0xcccccccc
s_mov_b32 s24, s12
s_mov_b32 s25, s13
s_lshl_b32 s46, s35, 10
s_add_u32 m0, s46, 114688
s_cmp_eq_u32 s52, 0
s_cbranch_scc1 L_k1_kernel_nowo
buffer_load_dwordx4 v9, s[24:27], s50 offen lds
L_k1_kernel_nowo:
s_add_u32 s54, s37, s53
s_add_u32 m0, s41, 16384
s_mul_i32 s56, s53, s40
buffer_load_dwordx4 v6, s[16:19], s54 offen lds
s_add_u32 s55, s38, s53
s_add_u32 m0, s42, 16384
s_add_u32 s56, s56, s39
buffer_load_dwordx4 v7, s[16:19], s55 offen lds
s_add_u32 m0, s43, 16384
s_add_u32 s53, s53, 128
buffer_load_dwordx4 v8, s[20:23], s56 offen lds
s_add_u32 m0, s43, 17408
s_cmp_eq_u32 s53, 896
s_cselect_b32 s53, 0, s53
buffer_load_dwordx4 v8, s[60:63], s56 offen lds
s_add_u32 s54, s37, s53
s_add_u32 m0, s41, 24576
s_mul_i32 s56, s53, s40
buffer_load_dwordx4 v6, s[16:19], s54 offen lds
s_add_u32 s55, s38, s53
s_add_u32 m0, s42, 24576
s_add_u32 s56, s56, s39
buffer_load_dwordx4 v7, s[16:19], s55 offen lds
s_add_u32 m0, s43, 24576
s_add_u32 s53, s53, 128
buffer_load_dwordx4 v8, s[20:23], s56 offen lds
s_add_u32 m0, s43, 25600
s_cmp_eq_u32 s53, 896
s_cselect_b32 s53, 0, s53
buffer_load_dwordx4 v8, s[60:63], s56 offen lds
s_mov_b32 s28, s14
s_mov_b32 s29, s15
s_waitcnt vmcnt(12)
s_barrier
ds_read_b64_tr_b16 v[88:89], v14 offset:0
ds_read_b64_tr_b16 v[90:91], v14 offset:256
ds_read_b128 v[92:95], v10 offset:0
ds_read_b128 v[120:123], v18 offset:0
ds_read_b64_tr_b16 v[96:97], v15 offset:0
ds_read_b64_tr_b16 v[98:99], v15 offset:256
ds_read_b128 v[100:103], v11 offset:0
ds_read_b64_tr_b16 v[104:105], v16 offset:0
ds_read_b64_tr_b16 v[106:107], v16 offset:256
ds_read_b128 v[108:111], v12 offset:0
ds_read_b128 v[124:127], v19 offset:0
ds_read_b64_tr_b16 v[112:113], v17 offset:0
ds_read_b64_tr_b16 v[114:115], v17 offset:256
ds_read_b128 v[116:119], v13 offset:0
s_waitcnt lgkmcnt(11)
v_mfma_f32_32x32x16_bf16 v[128:143], v[88:91], v[92:95], 0
s_waitcnt vmcnt(8)
s_barrier
ds_read_b64_tr_b16 v[48:49], v14 offset:8192
ds_read_b64_tr_b16 v[50:51], v14 offset:8448
ds_read_b128 v[52:55], v10 offset:8192
ds_read_b128 v[80:83], v18 offset:8192
v_mfma_f32_16x16x32_bf16 v[44:47], v[28:31], v[88:91], 0
ds_read_b64_tr_b16 v[56:57], v15 offset:8192
ds_read_b64_tr_b16 v[58:59], v15 offset:8448
s_waitcnt lgkmcnt(15)
v_mfma_f32_16x16x32_bf16 v[36:39], v[120:123], v[120:123], 0
ds_read_b128 v[60:63], v11 offset:8192
ds_read_b64_tr_b16 v[64:65], v16 offset:8192
s_waitcnt lgkmcnt(15)
v_mfma_f32_32x32x16_bf16 v[128:143], v[96:99], v[100:103], v[128:143]
ds_read_b64_tr_b16 v[66:67], v16 offset:8448
ds_read_b128 v[68:71], v12 offset:8192
ds_read_b128 v[84:87], v19 offset:8192
ds_read_b64_tr_b16 v[72:73], v17 offset:8192
ds_read_b64_tr_b16 v[74:75], v17 offset:8448
v_mfma_f32_16x16x32_bf16 v[40:43], v[32:35], v[120:123], 0
ds_read_b128 v[76:79], v13 offset:8192
s_add_u32 s54, s37, s53
s_waitcnt lgkmcnt(15)
v_mfma_f32_32x32x16_bf16 v[128:143], v[104:107], v[108:111], v[128:143]
s_add_u32 m0, s41, 32768
s_mul_i32 s56, s53, s40
buffer_load_dwordx4 v6, s[16:19], s54 offen lds
s_add_u32 s55, s38, s53
s_add_u32 m0, s42, 32768
v_mfma_f32_16x16x32_bf16 v[44:47], v[28:31], v[104:107], v[44:47]
s_add_u32 s56, s56, s39
buffer_load_dwordx4 v7, s[16:19], s55 offen lds
v_mfma_f32_16x16x32_bf16 v[36:39], v[124:127], v[124:127], v[36:39]
s_add_u32 m0, s43, 32768
s_add_u32 s53, s53, 128
s_waitcnt lgkmcnt(14)
v_mfma_f32_32x32x16_bf16 v[128:143], v[112:115], v[116:119], v[128:143]
buffer_load_dwordx4 v8, s[20:23], s56 offen lds
s_add_u32 m0, s43, 33792
s_cmp_eq_u32 s53, 896
s_cselect_b32 s53, 0, s53
buffer_load_dwordx4 v8, s[60:63], s56 offen lds
v_mfma_f32_16x16x32_bf16 v[40:43], v[32:35], v[124:127], v[40:43]
s_waitcnt lgkmcnt(11)
v_mfma_f32_32x32x16_bf16 v[128:143], v[48:51], v[52:55], v[128:143]
s_waitcnt vmcnt(8)
s_barrier
ds_read_b64_tr_b16 v[88:89], v14 offset:16384
ds_read_b64_tr_b16 v[90:91], v14 offset:16640
ds_read_b128 v[92:95], v10 offset:16384
ds_read_b128 v[120:123], v18 offset:16384
v_mfma_f32_16x16x32_bf16 v[44:47], v[28:31], v[48:51], v[44:47]
ds_read_b64_tr_b16 v[96:97], v15 offset:16384
ds_read_b64_tr_b16 v[98:99], v15 offset:16640
s_waitcnt lgkmcnt(15)
v_mfma_f32_16x16x32_bf16 v[36:39], v[80:83], v[80:83], v[36:39]
ds_read_b128 v[100:103], v11 offset:16384
ds_read_b64_tr_b16 v[104:105], v16 offset:16384
s_waitcnt lgkmcnt(15)
v_mfma_f32_32x32x16_bf16 v[128:143], v[56:59], v[60:63], v[128:143]
ds_read_b64_tr_b16 v[106:107], v16 offset:16640
ds_read_b128 v[108:111], v12 offset:16384
ds_read_b128 v[124:127], v19 offset:16384
ds_read_b64_tr_b16 v[112:113], v17 offset:16384
ds_read_b64_tr_b16 v[114:115], v17 offset:16640
v_mfma_f32_16x16x32_bf16 v[40:43], v[32:35], v[80:83], v[40:43]
ds_read_b128 v[116:119], v13 offset:16384
s_add_u32 s54, s37, s53
s_waitcnt lgkmcnt(15)
v_mfma_f32_32x32x16_bf16 v[128:143], v[64:67], v[68:71], v[128:143]
s_add_u32 m0, s41, 40960
s_mul_i32 s56, s53, s40
buffer_load_dwordx4 v6, s[16:19], s54 offen lds
s_add_u32 s55, s38, s53
s_add_u32 m0, s42, 40960
v_mfma_f32_16x16x32_bf16 v[44:47], v[28:31], v[64:67], v[44:47]
s_add_u32 s56, s56, s39
buffer_load_dwordx4 v7, s[16:19], s55 offen lds
v_mfma_f32_16x16x32_bf16 v[36:39], v[84:87], v[84:87], v[36:39]
s_add_u32 m0, s43, 40960
s_add_u32 s53, s53, 128
s_waitcnt lgkmcnt(14)
v_mfma_f32_32x32x16_bf16 v[128:143], v[72:75], v[76:79], v[128:143]
buffer_load_dwordx4 v8, s[20:23], s56 offen lds
s_add_u32 m0, s43, 41984
s_cmp_eq_u32 s53, 896
s_cselect_b32 s53, 0, s53
buffer_load_dwordx4 v8, s[60:63], s56 offen lds
v_mfma_f32_16x16x32_bf16 v[40:43], v[32:35], v[84:87], v[40:43]
s_waitcnt lgkmcnt(11)
v_mfma_f32_32x32x16_bf16 v[128:143], v[88:91], v[92:95], v[128:143]
s_waitcnt vmcnt(8)
s_barrier
ds_read_b64_tr_b16 v[48:49], v14 offset:24576
ds_read_b64_tr_b16 v[50:51], v14 offset:24832
ds_read_b128 v[52:55], v10 offset:24576
ds_read_b128 v[80:83], v18 offset:24576
v_mfma_f32_16x16x32_bf16 v[44:47], v[28:31], v[88:91], v[44:47]
ds_read_b64_tr_b16 v[56:57], v15 offset:24576
ds_read_b64_tr_b16 v[58:59], v15 offset:24832
s_waitcnt lgkmcnt(15)
v_mfma_f32_16x16x32_bf16 v[36:39], v[120:123], v[120:123], v[36:39]
ds_read_b128 v[60:63], v11 offset:24576
ds_read_b64_tr_b16 v[64:65], v16 offset:24576
s_waitcnt lgkmcnt(15)
v_mfma_f32_32x32x16_bf16 v[128:143], v[96:99], v[100:103], v[128:143]
ds_read_b64_tr_b16 v[66:67], v16 offset:24832
ds_read_b128 v[68:71], v12 offset:24576
ds_read_b128 v[84:87], v19 offset:24576
ds_read_b64_tr_b16 v[72:73], v17 offset:24576
ds_read_b64_tr_b16 v[74:75], v17 offset:24832
v_mfma_f32_16x16x32_bf16 v[40:43], v[32:35], v[120:123], v[40:43]
ds_read_b128 v[76:79], v13 offset:24576
s_add_u32 s54, s37, s53
s_waitcnt lgkmcnt(15)
v_mfma_f32_32x32x16_bf16 v[128:143], v[104:107], v[108:111], v[128:143]
s_add_u32 m0, s41, 49152
s_mul_i32 s56, s53, s40
buffer_load_dwordx4 v6, s[16:19], s54 offen lds
s_add_u32 s55, s38, s53
s_add_u32 m0, s42, 49152
v_mfma_f32_16x16x32_bf16 v[44:47], v[28:31], v[104:107], v[44:47]
s_add_u32 s56, s56, s39
buffer_load_dwordx4 v7, s[16:19], s55 offen lds
v_mfma_f32_16x16x32_bf16 v[36:39], v[124:127], v[124:127], v[36:39]
s_add_u32 m0, s43, 49152
s_add_u32 s53, s53, 128
s_waitcnt lgkmcnt(14)
v_mfma_f32_32x32x16_bf16 v[128:143], v[112:115], v[116:119], v[128:143]
buffer_load_dwordx4 v8, s[20:23], s56 offen lds
s_add_u32 m0, s43, 50176
s_cmp_eq_u32 s53, 896
s_cselect_b32 s53, 0, s53
buffer_load_dwordx4 v8, s[60:63], s56 offen lds
v_mfma_f32_16x16x32_bf16 v[40:43], v[32:35], v[124:127], v[40:43]
s_cmp_eq_u32 s52, 0
s_cbranch_scc1 L_k1_kernel_nowo2
ds_read_b64_tr_b16 v[144:145], v20
ds_read_b64_tr_b16 v[146:147], v20 offset:256
v_lshlrev_b32 v2, 4, v1
s_waitcnt lgkmcnt(0)
buffer_store_dwordx4 v[144:147], v2, s[28:31], s51 offen sc0 sc1
L_k1_kernel_nowo2:
s_waitcnt lgkmcnt(11)
v_mfma_f32_32x32x16_bf16 v[128:143], v[48:51], v[52:55], v[128:143]
s_waitcnt vmcnt(8)
s_barrier
ds_read_b64_tr_b16 v[88:89], v14 offset:32768
ds_read_b64_tr_b16 v[90:91], v14 offset:33024
ds_read_b128 v[92:95], v10 offset:32768
ds_read_b128 v[120:123], v18 offset:32768
v_mfma_f32_16x16x32_bf16 v[44:47], v[28:31], v[48:51], v[44:47]
ds_read_b64_tr_b16 v[96:97], v15 offset:32768
ds_read_b64_tr_b16 v[98:99], v15 offset:33024
s_waitcnt lgkmcnt(15)
v_mfma_f32_16x16x32_bf16 v[36:39], v[80:83], v[80:83], v[36:39]
ds_read_b128 v[100:103], v11 offset:32768
ds_read_b64_tr_b16 v[104:105], v16 offset:32768
s_waitcnt lgkmcnt(15)
v_mfma_f32_32x32x16_bf16 v[128:143], v[56:59], v[60:63], v[128:143]
ds_read_b64_tr_b16 v[106:107], v16 offset:33024
ds_read_b128 v[108:111], v12 offset:32768
ds_read_b128 v[124:127], v19 offset:32768
ds_read_b64_tr_b16 v[112:113], v17 offset:32768
ds_read_b64_tr_b16 v[114:115], v17 offset:33024
v_mfma_f32_16x16x32_bf16 v[40:43], v[32:35], v[80:83], v[40:43]
ds_read_b128 v[116:119], v13 offset:32768
v_mov_b32 v160, -1
s_waitcnt lgkmcnt(15)
v_mfma_f32_32x32x16_bf16 v[128:143], v[64:67], v[68:71], v[128:143]
v_mov_b32 v161, -1
v_mov_b32 v162, -1
v_mov_b32 v163, -1
v_lshlrev_b32 v164, 4, v0
s_lshl_b32 s46, s2, 12
v_mfma_f32_16x16x32_bf16 v[44:47], v[28:31], v[64:67], v[44:47]
s_add_u32 s46, s46, 0x270000
s_add_u32 s47, s46, 0x100000
v_mfma_f32_16x16x32_bf16 v[36:39], v[84:87], v[84:87], v[36:39]
s_cmp_lt_u32 s2, 23
s_cselect_b32 s47, s47, 0x10000000
s_waitcnt lgkmcnt(14)
v_mfma_f32_32x32x16_bf16 v[128:143], v[72:75], v[76:79], v[128:143]
buffer_store_dwordx4 v[160:163], v164, s[28:31], s46 offen sc1
buffer_store_dwordx4 v[160:163], v164, s[28:31], s47 offen sc1
v_mfma_f32_16x16x32_bf16 v[40:43], v[32:35], v[84:87], v[40:43]
s_waitcnt lgkmcnt(11)
v_mfma_f32_32x32x16_bf16 v[128:143], v[88:91], v[92:95], v[128:143]
s_waitcnt vmcnt(6)
s_barrier
ds_read_b64_tr_b16 v[48:49], v14 offset:40960
ds_read_b64_tr_b16 v[50:51], v14 offset:41216
ds_read_b128 v[52:55], v10 offset:40960
ds_read_b128 v[80:83], v18 offset:40960
v_mfma_f32_16x16x32_bf16 v[44:47], v[28:31], v[88:91], v[44:47]
ds_read_b64_tr_b16 v[56:57], v15 offset:40960
ds_read_b64_tr_b16 v[58:59], v15 offset:41216
s_waitcnt lgkmcnt(15)
v_mfma_f32_16x16x32_bf16 v[36:39], v[120:123], v[120:123], v[36:39]
ds_read_b128 v[60:63], v11 offset:40960
ds_read_b64_tr_b16 v[64:65], v16 offset:40960
s_waitcnt lgkmcnt(15)
v_mfma_f32_32x32x16_bf16 v[128:143], v[96:99], v[100:103], v[128:143]
ds_read_b64_tr_b16 v[66:67], v16 offset:41216
ds_read_b128 v[68:71], v12 offset:40960
ds_read_b128 v[84:87], v19 offset:40960
ds_read_b64_tr_b16 v[72:73], v17 offset:40960
ds_read_b64_tr_b16 v[74:75], v17 offset:41216
v_mfma_f32_16x16x32_bf16 v[40:43], v[32:35], v[120:123], v[40:43]
ds_read_b128 v[76:79], v13 offset:40960
s_waitcnt lgkmcnt(15)
v_mfma_f32_32x32x16_bf16 v[128:143], v[104:107], v[108:111], v[128:143]
v_mfma_f32_16x16x32_bf16 v[44:47], v[28:31], v[104:107], v[44:47]
v_mfma_f32_16x16x32_bf16 v[36:39], v[124:127], v[124:127], v[36:39]
s_waitcnt lgkmcnt(14)
v_mfma_f32_32x32x16_bf16 v[128:143], v[112:115], v[116:119], v[128:143]
v_mfma_f32_16x16x32_bf16 v[40:43], v[32:35], v[124:127], v[40:43]
s_waitcnt lgkmcnt(11)
v_mfma_f32_32x32x16_bf16 v[128:143], v[48:51], v[52:55], v[128:143]
s_waitcnt vmcnt(2)
s_barrier
ds_read_b128 v[120:123], v18 offset:49152
ds_read_b128 v[124:127], v19 offset:49152
ds_read_b64_tr_b16 v[88:89], v14 offset:49152
ds_read_b64_tr_b16 v[90:91], v14 offset:49408
v_mfma_f32_16x16x32_bf16 v[44:47], v[28:31], v[48:51], v[44:47]
ds_read_b64_tr_b16 v[104:105], v16 offset:49152
ds_read_b64_tr_b16 v[106:107], v16 offset:49408
s_waitcnt lgkmcnt(15)
v_mfma_f32_16x16x32_bf16 v[36:39], v[80:83], v[80:83], v[36:39]
ds_read_b128 v[92:95], v10 offset:49152
ds_read_b64_tr_b16 v[96:97], v15 offset:49152
s_waitcnt lgkmcnt(15)
v_mfma_f32_32x32x16_bf16 v[128:143], v[56:59], v[60:63], v[128:143]
ds_read_b64_tr_b16 v[98:99], v15 offset:49408
ds_read_b128 v[100:103], v11 offset:49152
ds_read_b128 v[108:111], v12 offset:49152
ds_read_b64_tr_b16 v[112:113], v17 offset:49152
ds_read_b64_tr_b16 v[114:115], v17 offset:49408
v_mfma_f32_16x16x32_bf16 v[40:43], v[32:35], v[80:83], v[40:43]
ds_read_b128 v[116:119], v13 offset:49152
s_waitcnt lgkmcnt(15)
v_mfma_f32_32x32x16_bf16 v[128:143], v[64:67], v[68:71], v[128:143]
v_mfma_f32_16x16x32_bf16 v[44:47], v[28:31], v[64:67], v[44:47]
v_mfma_f32_16x16x32_bf16 v[36:39], v[84:87], v[84:87], v[36:39]
s_waitcnt lgkmcnt(14)
v_mfma_f32_32x32x16_bf16 v[128:143], v[72:75], v[76:79], v[128:143]
v_mfma_f32_16x16x32_bf16 v[40:43], v[32:35], v[84:87], v[40:43]
s_waitcnt lgkmcnt(13)
v_mfma_f32_16x16x32_bf16 v[36:39], v[120:123], v[120:123], v[36:39]
v_mfma_f32_16x16x32_bf16 v[40:43], v[32:35], v[120:123], v[40:43]
s_waitcnt lgkmcnt(12)
v_mfma_f32_16x16x32_bf16 v[36:39], v[124:127], v[124:127], v[36:39]
v_mfma_f32_16x16x32_bf16 v[40:43], v[32:35], v[124:127], v[40:43]
s_waitcnt lgkmcnt(10)
v_mfma_f32_16x16x32_bf16 v[44:47], v[28:31], v[88:91], v[44:47]
s_waitcnt lgkmcnt(8)
v_mfma_f32_16x16x32_bf16 v[44:47], v[28:31], v[104:107], v[44:47]
s_waitcnt lgkmcnt(7)
v_mfma_f32_32x32x16_bf16 v[128:143], v[88:91], v[92:95], v[128:143]
s_waitcnt lgkmcnt(4)
v_mfma_f32_32x32x16_bf16 v[128:143], v[96:99], v[100:103], v[128:143]
v_cndmask_b32_e64 v36, v36, v37, s[64:65]
v_cndmask_b32_e64 v38, v38, v39, s[64:65]
s_nop 1
ds_write_b32 v23, v44
v_cndmask_b32_e64 v36, v36, v38, s[66:67]
v_mul_f32 v40, 0x3b124925, v40
v_mul_f32 v36, 0x3b124925, v36
v_fma_f32 v36, -v40, v40, v36
v_max_f32 v36, 0, v36
s_waitcnt lgkmcnt(4)
v_mfma_f32_32x32x16_bf16 v[128:143], v[104:107], v[108:111], v[128:143]
v_cvt_pk_bf16_f32 v146, 0, v40
v_cvt_pk_bf16_f32 v147, 0, v36
v_add_f32 v147, 0x3727c5ac, v147
v_cvt_pk_bf16_f32 v147, 0, v147
v_sqrt_f32 v147, v147
s_nop 0
v_cvt_pk_bf16_f32 v147, 0, v147
v_rcp_f32 v149, v147
s_waitcnt lgkmcnt(1)
v_mfma_f32_32x32x16_bf16 v[128:143], v[112:115], v[116:119], v[128:143]
v_mul_f32 v149, s45, v149
s_mov_b32 exec_lo, 0x00f0000f
s_mov_b32 exec_hi, 0xf0000f00
v_mul_f32_e64 v148, -v146, v149
ds_write_b64 v22, v[148:149]
s_mov_b64 exec, -1
s_waitcnt lgkmcnt(0)
s_barrier
ds_read_b64 v[148:149], v24
ds_read_b128 v[48:51], v25 offset:0
ds_read_b128 v[64:67], v25 offset:128
ds_read_b128 v[52:55], v25 offset:32
ds_read_b128 v[68:71], v25 offset:160
ds_read_b128 v[56:59], v25 offset:64
ds_read_b128 v[72:75], v25 offset:192
ds_read_b128 v[60:63], v25 offset:96
ds_read_b128 v[76:79], v25 offset:224
s_cmp_eq_u32 s34, 7
s_waitcnt lgkmcnt(6)
v_pk_add_f32 v[48:49], v[48:49], v[64:65]
v_pk_mul_f32 v[48:49], v[48:49], v[148:149] op_sel_hi:[1,0]
v_pk_fma_f32 v[48:49], v[128:129], v[148:149], v[48:49] op_sel:[0,1,0] op_sel_hi:[1,1,1]
v_cvt_pk_bf16_f32 v152, v48, v49
v_pk_add_f32 v[50:51], v[50:51], v[66:67]
v_pk_mul_f32 v[50:51], v[50:51], v[148:149] op_sel_hi:[1,0]
v_pk_fma_f32 v[50:51], v[130:131], v[148:149], v[50:51] op_sel:[0,1,0] op_sel_hi:[1,1,1]
v_cvt_pk_bf16_f32 v153, v50, v51
s_waitcnt lgkmcnt(4)
v_pk_add_f32 v[52:53], v[52:53], v[68:69]
v_pk_mul_f32 v[52:53], v[52:53], v[148:149] op_sel_hi:[1,0]
v_pk_fma_f32 v[52:53], v[132:133], v[148:149], v[52:53] op_sel:[0,1,0] op_sel_hi:[1,1,1]
v_cvt_pk_bf16_f32 v154, v52, v53
v_pk_add_f32 v[54:55], v[54:55], v[70:71]
v_pk_mul_f32 v[54:55], v[54:55], v[148:149] op_sel_hi:[1,0]
v_pk_fma_f32 v[54:55], v[134:135], v[148:149], v[54:55] op_sel:[0,1,0] op_sel_hi:[1,1,1]
v_cvt_pk_bf16_f32 v155, v54, v55
s_waitcnt lgkmcnt(2)
v_pk_add_f32 v[56:57], v[56:57], v[72:73]
v_pk_mul_f32 v[56:57], v[56:57], v[148:149] op_sel_hi:[1,0]
v_pk_fma_f32 v[56:57], v[136:137], v[148:149], v[56:57] op_sel:[0,1,0] op_sel_hi:[1,1,1]
v_cvt_pk_bf16_f32 v156, v56, v57
v_pk_add_f32 v[58:59], v[58:59], v[74:75]
v_pk_mul_f32 v[58:59], v[58:59], v[148:149] op_sel_hi:[1,0]
v_pk_fma_f32 v[58:59], v[138:139], v[148:149], v[58:59] op_sel:[0,1,0] op_sel_hi:[1,1,1]
v_cvt_pk_bf16_f32 v157, v58, v59
s_waitcnt lgkmcnt(0)
v_pk_add_f32 v[60:61], v[60:61], v[76:77]
v_pk_mul_f32 v[60:61], v[60:61], v[148:149] op_sel_hi:[1,0]
v_pk_fma_f32 v[60:61], v[140:141], v[148:149], v[60:61] op_sel:[0,1,0] op_sel_hi:[1,1,1]
v_cvt_pk_bf16_f32 v158, v60, v61
v_pk_add_f32 v[62:63], v[62:63], v[78:79]
s_branch L_pf_s0
.p2align 12
L_pf_p0:
L_pf_e0_0:
L_pf_e0_1:
s_sub_u32 s71, s71, 1
s_cbranch_scc1 L_pf_ret
s_branch L_pf_p2
L_pf_s0:
v_pk_mul_f32 v[62:63], v[62:63], v[148:149] op_sel_hi:[1,0]
v_pk_fma_f32 v[62:63], v[142:143], v[148:149], v[62:63] op_sel:[0,1,0] op_sel_hi:[1,1,1]
v_cvt_pk_bf16_f32 v159, v62, v63
s_cbranch_scc1 L_k1_kernel_kv
v_permlane32_swap_b32 v152, v154
v_permlane32_swap_b32 v153, v155
v_permlane32_swap_b32 v156, v158
v_permlane32_swap_b32 v157, v159
buffer_store_dwordx4 v[152:155], v21, s[28:31], s57 offen sc0 sc1
buffer_store_dwordx4 v[156:159], v21, s[28:31], s57 offen offset:256 sc0 sc1
s_endpgm
L_k1_kernel_kv:
v_lshlrev_b32 v21, 4, v1
s_cmp_eq_u32 s36, 1
s_mov_b32 exec_lo, 0
s_cbranch_scc1 L_k1_kernel_v
v_mov_b32 v158, v32
v_mov_b32 v159, 0x3f80
s_mov_b32 exec_lo, -1
buffer_store_dwordx4 v[152:155], v21, s[28:31], s57 offen sc0 sc1
buffer_store_dwordx4 v[156:159], v21, s[28:31], s57 offen offset:1024 sc0 sc1
s_endpgm
L_k1_kernel_v:
v_mov_b32 v158, 0x3f80
v_mov_b32 v159, 0
s_mov_b32 exec_lo, -1
s_lshl_b32 s46, s35, 11
s_add_u32 s46, s46, 117760
v_and_b32 v2, 31, v1
v_lshlrev_b32 v2, 6, v2
v_bfe_u32 v3, v1, 1, 1
v_lshl_add_u32 v2, v3, 5, v2
v_lshrrev_b32 v3, 5, v1
v_lshl_add_u32 v2, v3, 3, v2
v_add_u32 v2, s46, v2
v_xor_b32 v3, 32, v2
v_add_u32 v26, s46, v26
ds_write_b64 v2, v[152:153]
ds_write_b64 v2, v[154:155] offset:16
ds_write_b64 v3, v[156:157]
ds_write_b64 v3, v[158:159] offset:16
ds_read_b64_tr_b16 v[48:49], v26 offset:0
ds_read_b64_tr_b16 v[50:51], v26 offset:512
ds_read_b64_tr_b16 v[52:53], v26 offset:1024
ds_read_b64_tr_b16 v[54:55], v26 offset:1536
s_waitcnt lgkmcnt(2)
buffer_store_dwordx4 v[48:51], v21, s[28:31], s57 offen offset:2048 sc0 sc1
s_waitcnt lgkmcnt(0)
buffer_store_dwordx4 v[52:55], v21, s[28:31], s57 offen offset:3072 sc0 sc1
s_endpgm
L_k1_kernel_end:
s_endpgm
.p2align 12
.fill 509, 4, 0xbf800000
L_pf_p1:
L_pf_e1_0:
L_pf_e1_1:
s_sub_u32 s71, s71, 1
s_cbranch_scc1 L_pf_ret
s_branch L_pf_p3
.globl k2_kernel
.p2align 8
.type k2_kernel,@function
k2_kernel:
s_cmp_ge_u32 s2, 256
s_cbranch_scc1 L_k2_kernel_end
s_load_dwordx2 s[10:11], s[0:1], 96
s_load_dwordx8 s[60:67], s[0:1], 48
s_load_dwordx2 s[4:5], s[0:1], 0
s_load_dwordx2 s[8:9], s[0:1], 80
v_and_b32 v1, 63, v0
v_lshrrev_b32 v3, 6, v0
s_nop 0
v_readfirstlane_b32 s36, v3
v_lshlrev_b32 v0, 4, v1
v_add_u32 v2, 4096, v0
v_add_u32 v252, 8192, v0
v_add_u32 v253, 12288, v0
s_and_b32 s46, s2, 7
s_lshl_b32 s46, s46, 3
s_bfe_u32 s47, s2, 0x30003
s_or_b32 s46, s46, s47
s_and_b32 s47, s2, 0xc0
s_or_b32 s37, s46, s47
s_mul_i32 s50, s37, 7168
s_lshr_b32 s38, s2, 3
s_and_b32 s53, s38, 15
s_lshl_b32 s53, s53, 12
s_mov_b32 s14, 0x400000
s_mov_b32 s15, 0x20000
s_mov_b32 s18, 65536
s_mov_b32 s19, 0x20000
s_lshl_b32 s46, s36, 16
s_add_u32 s46, s46, 0x1c0000
s_mul_i32 s48, s36, 1792
s_add_u32 s41, s48, s50
s_mul_i32 s42, s36, 1984
s_add_u32 s42, s42, 8192
v_mul_u32_u24 v48, 37, v1
v_lshrrev_b32 v48, 9, v48
v_mul_i32_i24 v48, -1776, v48
v_lshl_add_u32 v48, v1, 7, v48
s_mov_b32 s45, 0
v_mov_b32 v28, 0
v_mov_b32 v29, 0
v_mov_b32 v30, 0
v_mov_b32 v31, 0
v_mov_b32 v32, 0
v_mov_b32 v33, 0
v_mov_b32 v34, 0
v_mov_b32 v35, 0
v_and_b32 v4, 15, v1
v_mul_u32_u24 v4, 56, v4
v_lshrrev_b32 v5, 5, v1
v_lshl_add_u32 v7, v5, 3, v4
v_bfe_i32 v254, v1, 1, 1
v_and_b32 v254, 0xaaaaaaaa, v254
v_or_b32 v254, 0x44444444, v254
s_mul_i32 s78, s36, 5120
s_add_u32 s78, s78, 57936
v_lshl_add_u32 v255, v1, 3, s78
s_waitcnt lgkmcnt(0)
s_mov_b32 s12, s10
s_mov_b32 s13, s11
s_add_u32 s16, s10, s46
s_addc_u32 s17, s11, 0
L_k2_kernel_start:
s_mov_b32 s39, s53
s_mov_b32 m0, s42
s_mov_b32 exec_hi, 0x00ffffff
buffer_load_dwordx4 v48, s[12:15], s41 offen lds
s_add_u32 m0, s42, 832
s_nop 0
buffer_load_dwordx4 v48, s[12:15], s41 offen offset:64 lds
s_mov_b32 exec_hi, -1
buffer_load_dwordx4 v[52:55], v0, s[16:19], s39 offen offset:0
buffer_load_dwordx4 v[56:59], v0, s[16:19], s39 offen offset:1024
buffer_load_dwordx4 v[60:63], v0, s[16:19], s39 offen offset:2048
buffer_load_dwordx4 v[64:67], v0, s[16:19], s39 offen offset:3072
v_accvgpr_write_b32 a54, v28
v_accvgpr_write_b32 a55, v29
v_accvgpr_write_b32 a62, v30
v_accvgpr_write_b32 a63, v31
v_accvgpr_write_b32 a70, v32
v_accvgpr_write_b32 a71, v33
v_accvgpr_write_b32 a78, v34
v_accvgpr_write_b32 a79, v35
v_bfe_u32 v49, v1, 4, 1
v_mul_u32_u24 v49, 224, v49
v_bfe_u32 v50, v1, 2, 2
v_mul_u32_u24 v50, 1760, v50
v_add3_u32 v49, v49, v50, v7
s_add_u32 s46, s36, 0
s_and_b32 s46, s46, 3
s_mul_i32 s46, s46, 448
s_add_u32 s46, s46, 8192
v_add_u32 v44, s46, v49
s_add_u32 s46, s36, 1
s_and_b32 s46, s46, 3
s_mul_i32 s46, s46, 448
s_add_u32 s46, s46, 8192
v_add_u32 v45, s46, v49
s_add_u32 s46, s36, 2
s_and_b32 s46, s46, 3
s_mul_i32 s46, s46, 448
s_add_u32 s46, s46, 8192
v_add_u32 v46, s46, v49
s_add_u32 s46, s36, 3
s_and_b32 s46, s46, 3
s_mul_i32 s46, s46, 448
s_add_u32 s46, s46, 8192
v_add_u32 v47, s46, v49
s_mul_i32 s46, s38, 37
s_lshr_b32 s46, s46, 8
s_mul_i32 s46, s46, 7
s_sub_u32 s51, s38, s46
s_mul_i32 s54, s51, 14336
s_mov_b32 s22, 100352
s_mov_b32 s23, 0x20000
s_mov_b32 s26, 1835008
s_mov_b32 s27, 0x20000
s_mov_b32 s30, 1835008
s_mov_b32 s31, 0x20000
s_mov_b32 s34, 896
s_mov_b32 s35, 0x20000
s_mul_i32 s47, s36, 100352
s_add_u32 s47, s47, 0x200000
s_add_u32 s20, s12, s47
s_addc_u32 s21, s13, 0
s_mov_b32 s24, s4
s_mov_b32 s25, s5
s_mov_b32 s28, s8
s_mov_b32 s29, s9
s_mov_b32 s32, s60
s_mov_b32 s33, s61
s_mul_i32 s56, s36, 224
s_add_u32 s55, s56, s50
v_bfe_u32 v3, v1, 4, 1
s_mul_i32 s47, s36, 1808
s_add_u32 s47, s47, 49152
v_mul_u32_u24 v3, 448, v3
s_lshl_b32 s46, s51, 6
v_lshrrev_b32 v7, 1, v7
v_subrev_u32 v7, s46, v7
v_add_u32 v4, 0, v7
v_add_u32 v5, 448, v7
v_min_u32 v4, v4, v5
v_add3_u32 v160, v4, v3, s47
v_add_u32 v4, 8, v7
v_add_u32 v5, 456, v7
v_min_u32 v4, v4, v5
v_add3_u32 v161, v4, v3, s47
v_add_u32 v4, 16, v7
v_add_u32 v5, 464, v7
v_min_u32 v4, v4, v5
v_add3_u32 v162, v4, v3, s47
v_add_u32 v4, 24, v7
v_add_u32 v5, 472, v7
v_min_u32 v4, v4, v5
v_add3_u32 v163, v4, v3, s47
v_and_b32 v213, 15, v1
v_lshlrev_b32 v213, 1, v213
v_add_u32 v7, s78, v213
v_lshrrev_b32 v4, 5, v1
v_lshl_add_u32 v4, v4, 10, v7
v_add_u32 v3, v3, v4
v_bfe_u32 v4, v1, 2, 2
v_mul_u32_u24 v4, 1808, v4
v_and_b32 v5, 3, v1
v_mul_u32_u24 v5, 448, v5
v_lshrrev_b32 v212, 4, v1
v_lshl_add_u32 v4, v212, 4, v4
s_movk_i32 s46, 0xc000
s_branch L_pf_s2
L_pf_p2:
L_pf_e0_2:
s_sub_u32 s71, s71, 1
s_cbranch_scc1 L_pf_ret
s_branch L_pf_p4
L_pf_s2:
s_and_b32 s46, s46, 0xffff
v_add3_u32 v4, v4, v5, s46
v_lshl_add_u32 v158, v212, 1, v1
v_and_b32 v158, 7, v158
v_lshlrev_b32 v156, 4, v158
v_add_u32 v156, 57424, v156
s_lshl_b32 s46, s37, 4
s_or_b32 s46, s46, 8
v_or_b32 v158, s46, v158
s_lshl_b32 s46, s36, 7
s_add_u32 s46, s46, 57424
v_lshrrev_b32 v157, 2, v1
v_lshl_add_u32 v157, v157, 3, s46
v_mul_u32_u24 v159, 3616, v212
v_add3_u32 v159, v159, v213, s56
ds_write2st64_b64 v255, v[156:157], v[158:159] offset0:6 offset1:7
ds_write2st64_b64 v255, v[160:161], v[162:163] offset0:8 offset1:9
v_mul_u32_u24 v224, 37, v1
v_lshrrev_b32 v224, 9, v224
v_mul_u32_u24 v224, 672, v224
v_add_u32 v224, v224, v0
s_mov_b32 s70, 1605632
s_mov_b32 s71, 0x20000
s_and_b32 s46, s2, 7
s_mul_i32 s47, s38, 50176
s_mul_i32 s48, s46, 448
s_andn2_b32 s48, s48, 127
s_add_u32 s48, s48, s47
s_lshl_b32 s49, s36, 7
s_add_u32 s48, s48, s49
s_add_u32 s94, s62, s48
s_addc_u32 s95, s63, 0
s_add_u32 s96, s64, s48
s_addc_u32 s97, s65, 0
s_min_u32 s46, s46, 6
s_lshl_b32 s46, s46, 7
s_add_u32 s46, s46, s47
s_mul_i32 s49, s36, 12544
s_add_u32 s46, s46, s49
s_add_u32 s98, s66, s46
s_addc_u32 s99, s67, 0
s_add_u32 s46, s36, 1
s_and_b32 s46, s46, 3
s_mul_i32 s46, s46, 12288
s_add_u32 s46, s46, 0
v_add_u32 v8, s46, v0
s_add_u32 s46, s36, 2
s_and_b32 s46, s46, 3
s_mul_i32 s46, s46, 12288
s_add_u32 s46, s46, 4096
v_add_u32 v9, s46, v0
s_add_u32 s46, s36, 3
s_and_b32 s46, s46, 3
s_mul_i32 s46, s46, 12288
s_add_u32 s46, s46, 8192
v_add_u32 v10, s46, v0
s_add_u32 s46, s36, 0
s_and_b32 s46, s46, 3
s_mul_i32 s46, s46, 12288
s_add_u32 s46, s46, 0
v_add_u32 v11, s46, v0
s_xor_b32 s11, s53, 0x1000
buffer_load_dwordx4 v[68:71], v0, s[16:19], s11 offen offset:0
buffer_load_dwordx4 v[72:75], v0, s[16:19], s11 offen offset:1024
s_xor_b32 s39, s53, 0x2000
s_mul_i32 s75, s36, 14336
s_add_u32 s75, s75, 78416
s_and_b32 s46, s2, 7
s_mul_i32 s47, s46, 14
s_add_u32 s47, s47, s38
s_lshl_b32 s48, s46, 2
s_add_u32 s48, s48, s38
s_sub_u32 s48, s48, 14
s_cmp_lt_u32 s46, 7
s_cselect_b32 s76, 2, 0
s_cmp_lt_u32 s2, 144
s_cselect_b32 s76, s76, 0
s_bitcmp1_b32 s36, 0
s_cselect_b32 s68, s64, s62
s_cselect_b32 s69, s65, s63
s_lshr_b32 s49, s36, 1
s_mul_i32 s49, s49, 802816
s_mul_i32 s46, s36, 401408
s_cmp_eq_u32 s36, 0
s_cselect_b32 s72, 1, 0
s_cmp_eq_u32 s76, 0
s_cselect_b32 s46, 0x10000000, s46
s_cmp_lt_u32 s2, 112
s_cselect_b32 s68, s68, s66
s_cselect_b32 s69, s69, s67
s_cselect_b32 s77, s47, s48
s_cselect_b32 s76, s72, s76
s_cselect_b32 s72, s49, s46
s_cselect_b32 s46, 4, 1
s_mul_i32 s46, s46, 896
s_lshl_b32 s73, s46, 5
s_lshl_b32 s47, s77, 5
s_add_u32 s72, s72, s47
v_lshrrev_b32 v5, 1, v1
v_mul_u32_u24 v5, s46, v5
s_and_b32 s58, s2, 7
s_lshl_b32 s58, s58, 5
s_add_u32 s58, s58, s38
s_lshl_b32 s86, s58, 3
s_add_u32 s86, s86, 0x370000
s_cmp_eq_u32 s36, 3
s_cselect_b32 s86, s86, 0x10000000
v_and_or_b32 v5, v0, 16, v5
s_lshl_b32 s84, s37, 12
s_add_u32 s84, s84, 0x270000
s_and_b32 s85, s2, 15
s_lshl_b32 s85, s85, 11
s_add_u32 s85, s85, 0x370000
s_waitcnt vmcnt(6)
s_barrier
ds_read_b64 a[56:57], v45 offset:0
ds_read_b64 a[58:59], v45 offset:16
ds_read_b64 a[60:61], v45 offset:32
s_mov_b32 exec_hi, 0
ds_read_b64 a[62:63], v45 offset:48
s_mov_b32 exec_hi, -1
ds_read_b64 a[64:65], v46 offset:0
ds_read_b64 a[66:67], v46 offset:16
ds_read_b64 a[68:69], v46 offset:32
s_mov_b32 exec_hi, 0
ds_read_b64 a[70:71], v46 offset:48
s_mov_b32 exec_hi, -1
ds_read_b64 a[72:73], v47 offset:0
ds_read_b64 a[74:75], v47 offset:16
ds_read_b64 a[76:77], v47 offset:32
s_mov_b32 exec_hi, 0
ds_read_b64 a[78:79], v47 offset:48
s_mov_b32 exec_hi, -1
ds_read_b64 a[48:49], v44 offset:0
ds_read_b64 a[50:51], v44 offset:16
ds_read_b64 a[52:53], v44 offset:32
s_mov_b32 exec_hi, 0
ds_read_b64 a[54:55], v44 offset:48
s_mov_b32 exec_hi, -1
s_waitcnt vmcnt(5) lgkmcnt(14)
v_mfma_f32_32x32x16_bf16 v[12:27], v[52:55], a[56:59], 0
s_waitcnt vmcnt(4) lgkmcnt(12)
v_mfma_f32_32x32x16_bf16 v[12:27], v[56:59], a[60:63], v[12:27]
s_waitcnt lgkmcnt(10)
v_mfma_f32_32x32x16_bf16 v[28:43], v[52:55], a[64:67], 0
s_waitcnt lgkmcnt(8)
buffer_load_dwordx4 v[76:79], v0, s[16:19], s11 offen offset:2048
s_nop 7
v_exp_f32 v12, v12
v_exp_f32 v13, v13
v_exp_f32 v14, v14
v_exp_f32 v15, v15
v_cvt_pk_bf16_f32 v44, v12, v13
v_cvt_pk_bf16_f32 v45, v14, v15
v_exp_f32 v16, v16
v_exp_f32 v17, v17
v_exp_f32 v18, v18
v_exp_f32 v19, v19
v_cvt_pk_bf16_f32 v46, v16, v17
v_cvt_pk_bf16_f32 v47, v18, v19
v_mfma_f32_32x32x16_bf16 v[28:43], v[56:59], a[68:71], v[28:43]
s_waitcnt vmcnt(4)
buffer_load_dwordx4 v[80:83], v0, s[16:19], s11 offen offset:3072
v_exp_f32 v20, v20
v_exp_f32 v21, v21
v_exp_f32 v22, v22
v_exp_f32 v23, v23
v_cvt_pk_bf16_f32 v48, v20, v21
v_cvt_pk_bf16_f32 v49, v22, v23
v_mfma_f32_32x32x16_bf16 a[0:15], v[60:63], v[44:47], 0
s_waitcnt lgkmcnt(6)
buffer_load_dwordx4 v[84:87], v0, s[16:19], s39 offen offset:0
v_exp_f32 v24, v24
v_exp_f32 v25, v25
v_exp_f32 v26, v26
v_exp_f32 v27, v27
v_cvt_pk_bf16_f32 v50, v24, v25
v_cvt_pk_bf16_f32 v51, v26, v27
v_mfma_f32_32x32x16_bf16 v[12:27], v[52:55], a[72:75], 0
s_waitcnt vmcnt(5)
s_branch L_pf_s3
.p2align 12
L_pf_p3:
L_pf_e1_2:
s_sub_u32 s71, s71, 1
s_cbranch_scc1 L_pf_ret
s_branch L_pf_p5
L_pf_s3:
buffer_load_dwordx4 v[88:91], v0, s[16:19], s39 offen offset:1024
v_exp_f32 v28, v28
v_exp_f32 v29, v29
v_exp_f32 v30, v30
v_exp_f32 v31, v31
v_cvt_pk_bf16_f32 v44, v28, v29
v_cvt_pk_bf16_f32 v45, v30, v31
v_mfma_f32_32x32x16_bf16 a[0:15], v[64:67], v[48:51], a[0:15]
s_waitcnt lgkmcnt(4)
buffer_load_dwordx4 v[92:95], v0, s[16:19], s39 offen offset:2048
v_exp_f32 v32, v32
v_exp_f32 v33, v33
v_exp_f32 v34, v34
v_exp_f32 v35, v35
v_cvt_pk_bf16_f32 v46, v32, v33
v_cvt_pk_bf16_f32 v47, v34, v35
v_mfma_f32_32x32x16_bf16 v[12:27], v[56:59], a[76:79], v[12:27]
buffer_load_dwordx4 v[96:99], v0, s[16:19], s39 offen offset:3072
v_exp_f32 v36, v36
v_exp_f32 v37, v37
v_exp_f32 v38, v38
v_exp_f32 v39, v39
v_cvt_pk_bf16_f32 v48, v36, v37
v_cvt_pk_bf16_f32 v49, v38, v39
v_mfma_f32_32x32x16_bf16 a[16:31], v[60:63], v[44:47], 0
s_waitcnt lgkmcnt(2)
v_exp_f32 v40, v40
v_exp_f32 v41, v41
v_exp_f32 v42, v42
v_exp_f32 v43, v43
v_cvt_pk_bf16_f32 v50, v40, v41
v_cvt_pk_bf16_f32 v51, v42, v43
v_mfma_f32_32x32x16_bf16 v[28:43], v[52:55], a[48:51], 0
s_xor_b32 s11, s53, 0x3000
v_exp_f32 v12, v12
v_exp_f32 v13, v13
v_exp_f32 v14, v14
v_exp_f32 v15, v15
v_cvt_pk_bf16_f32 v44, v12, v13
v_cvt_pk_bf16_f32 v45, v14, v15
v_mfma_f32_32x32x16_bf16 a[16:31], v[64:67], v[48:51], a[16:31]
s_waitcnt lgkmcnt(0)
buffer_load_dwordx4 v[228:231], v0, s[20:23], s54 offen offset:2048
v_exp_f32 v16, v16
v_exp_f32 v17, v17
v_exp_f32 v18, v18
v_exp_f32 v19, v19
v_cvt_pk_bf16_f32 v46, v16, v17
v_cvt_pk_bf16_f32 v47, v18, v19
v_mfma_f32_32x32x16_bf16 v[28:43], v[56:59], a[52:55], v[28:43]
s_xor_b32 s39, s53, 0x4000
v_exp_f32 v20, v20
v_exp_f32 v21, v21
v_exp_f32 v22, v22
v_exp_f32 v23, v23
v_cvt_pk_bf16_f32 v48, v20, v21
v_cvt_pk_bf16_f32 v49, v22, v23
v_mfma_f32_32x32x16_bf16 a[32:47], v[60:63], v[44:47], 0
s_waitcnt vmcnt(8)
buffer_load_dwordx4 a[112:115], v0, s[20:23], s54 offen offset:3072
v_exp_f32 v24, v24
v_exp_f32 v25, v25
v_exp_f32 v26, v26
v_exp_f32 v27, v27
v_cvt_pk_bf16_f32 v50, v24, v25
v_cvt_pk_bf16_f32 v51, v26, v27
v_mfma_f32_32x32x16_bf16 v[12:27], v[68:71], a[56:59], 0
s_load_dwordx2 s[88:89], s[94:95], 0x3c
buffer_load_dwordx4 v[52:55], v0, s[16:19], s11 offen offset:0
v_exp_f32 v28, v28
v_exp_f32 v29, v29
v_exp_f32 v30, v30
v_exp_f32 v31, v31
v_cvt_pk_bf16_f32 v44, v28, v29
v_cvt_pk_bf16_f32 v45, v30, v31
v_mfma_f32_32x32x16_bf16 a[32:47], v[64:67], v[48:51], a[32:47]
s_waitcnt vmcnt(9)
buffer_load_dwordx4 v[56:59], v0, s[16:19], s11 offen offset:1024
v_exp_f32 v32, v32
v_exp_f32 v33, v33
v_exp_f32 v34, v34
v_exp_f32 v35, v35
v_cvt_pk_bf16_f32 v46, v32, v33
v_cvt_pk_bf16_f32 v47, v34, v35
v_mfma_f32_32x32x16_bf16 v[12:27], v[72:75], a[60:63], v[12:27]
s_add_u32 s80, s54, 14336
v_exp_f32 v36, v36
v_exp_f32 v37, v37
v_exp_f32 v38, v38
v_exp_f32 v39, v39
v_cvt_pk_bf16_f32 v48, v36, v37
v_cvt_pk_bf16_f32 v49, v38, v39
v_mfma_f32_32x32x16_bf16 v[100:115], v[60:63], v[44:47], 0
s_sub_u32 s10, s80, 100352
v_exp_f32 v40, v40
v_exp_f32 v41, v41
v_exp_f32 v42, v42
v_exp_f32 v43, v43
v_cvt_pk_bf16_f32 v50, v40, v41
v_cvt_pk_bf16_f32 v51, v42, v43
v_mfma_f32_32x32x16_bf16 v[28:43], v[68:71], a[64:67], 0
s_min_u32 s80, s80, s10
v_exp_f32 v12, v12
v_exp_f32 v13, v13
v_exp_f32 v14, v14
v_exp_f32 v15, v15
v_cvt_pk_bf16_f32 v44, v12, v13
v_cvt_pk_bf16_f32 v45, v14, v15
v_mfma_f32_32x32x16_bf16 v[100:115], v[64:67], v[48:51], v[100:115]
s_load_dwordx2 s[88:89], s[96:97], 0x3c
buffer_load_dwordx4 a[168:171], v2, s[20:23], s54 offen offset:0
v_exp_f32 v16, v16
v_exp_f32 v17, v17
v_exp_f32 v18, v18
v_exp_f32 v19, v19
v_cvt_pk_bf16_f32 v46, v16, v17
v_cvt_pk_bf16_f32 v47, v18, v19
v_mfma_f32_32x32x16_bf16 v[28:43], v[72:75], a[68:71], v[28:43]
s_waitcnt vmcnt(9)
buffer_load_dwordx4 v[60:63], v0, s[16:19], s11 offen offset:2048
v_exp_f32 v20, v20
v_exp_f32 v21, v21
v_exp_f32 v22, v22
v_exp_f32 v23, v23
v_cvt_pk_bf16_f32 v48, v20, v21
v_cvt_pk_bf16_f32 v49, v22, v23
v_mfma_f32_32x32x16_bf16 a[0:15], v[76:79], v[44:47], a[0:15]
buffer_load_dwordx4 v[64:67], v0, s[16:19], s11 offen offset:3072
v_exp_f32 v24, v24
v_exp_f32 v25, v25
v_exp_f32 v26, v26
v_exp_f32 v27, v27
v_cvt_pk_bf16_f32 v50, v24, v25
v_cvt_pk_bf16_f32 v51, v26, v27
v_mfma_f32_32x32x16_bf16 v[12:27], v[68:71], a[72:75], 0
s_xor_b32 s11, s53, 0x5000
v_exp_f32 v28, v28
v_exp_f32 v29, v29
v_exp_f32 v30, v30
v_exp_f32 v31, v31
v_cvt_pk_bf16_f32 v44, v28, v29
v_cvt_pk_bf16_f32 v45, v30, v31
v_mfma_f32_32x32x16_bf16 a[0:15], v[80:83], v[48:51], a[0:15]
s_add_u32 s81, s80, 14336
v_exp_f32 v32, v32
v_exp_f32 v33, v33
v_exp_f32 v34, v34
v_exp_f32 v35, v35
v_cvt_pk_bf16_f32 v46, v32, v33
v_cvt_pk_bf16_f32 v47, v34, v35
v_mfma_f32_32x32x16_bf16 v[12:27], v[72:75], a[76:79], v[12:27]
s_load_dwordx2 s[88:89], s[98:99], 0x3c
buffer_load_dwordx4 a[224:227], v2, s[20:23], s54 offen offset:1024
v_exp_f32 v36, v36
v_exp_f32 v37, v37
v_exp_f32 v38, v38
v_exp_f32 v39, v39
v_cvt_pk_bf16_f32 v48, v36, v37
v_cvt_pk_bf16_f32 v49, v38, v39
v_mfma_f32_32x32x16_bf16 a[16:31], v[76:79], v[44:47], a[16:31]
s_sub_u32 s10, s81, 100352
v_exp_f32 v40, v40
v_exp_f32 v41, v41
v_exp_f32 v42, v42
v_exp_f32 v43, v43
v_cvt_pk_bf16_f32 v50, v40, v41
v_cvt_pk_bf16_f32 v51, v42, v43
v_mfma_f32_32x32x16_bf16 v[28:43], v[68:71], a[48:51], 0
buffer_load_dwordx4 a[240:243], v2, s[20:23], s54 offen offset:2048
v_exp_f32 v12, v12
v_exp_f32 v13, v13
v_exp_f32 v14, v14
v_exp_f32 v15, v15
v_cvt_pk_bf16_f32 v44, v12, v13
v_cvt_pk_bf16_f32 v45, v14, v15
v_mfma_f32_32x32x16_bf16 a[16:31], v[80:83], v[48:51], a[16:31]
s_min_u32 s81, s81, s10
v_exp_f32 v16, v16
v_exp_f32 v17, v17
v_exp_f32 v18, v18
v_exp_f32 v19, v19
v_cvt_pk_bf16_f32 v46, v16, v17
v_cvt_pk_bf16_f32 v47, v18, v19
v_mfma_f32_32x32x16_bf16 v[28:43], v[72:75], a[52:55], v[28:43]
s_load_dwordx2 s[88:89], s[94:95], 0xe3c
buffer_load_dwordx4 v[116:119], v0, s[20:23], s54 offen offset:0
v_exp_f32 v20, v20
v_exp_f32 v21, v21
v_exp_f32 v22, v22
v_exp_f32 v23, v23
v_cvt_pk_bf16_f32 v48, v20, v21
v_cvt_pk_bf16_f32 v49, v22, v23
v_mfma_f32_32x32x16_bf16 a[32:47], v[76:79], v[44:47], a[32:47]
s_waitcnt vmcnt(12)
buffer_load_dwordx4 v[172:175], v0, s[20:23], s54 offen offset:1024
v_exp_f32 v24, v24
v_exp_f32 v25, v25
v_exp_f32 v26, v26
v_exp_f32 v27, v27
v_cvt_pk_bf16_f32 v50, v24, v25
v_cvt_pk_bf16_f32 v51, v26, v27
v_mfma_f32_32x32x16_bf16 v[12:27], v[84:87], a[56:59], 0
buffer_load_dwordx4 v[68:71], v0, s[16:19], s39 offen offset:0
v_exp_f32 v28, v28
v_exp_f32 v29, v29
v_exp_f32 v30, v30
v_exp_f32 v31, v31
v_cvt_pk_bf16_f32 v44, v28, v29
v_cvt_pk_bf16_f32 v45, v30, v31
v_mfma_f32_32x32x16_bf16 a[32:47], v[80:83], v[48:51], a[32:47]
buffer_load_dwordx4 v[72:75], v0, s[16:19], s39 offen offset:1024
v_exp_f32 v32, v32
v_exp_f32 v33, v33
v_exp_f32 v34, v34
v_exp_f32 v35, v35
v_cvt_pk_bf16_f32 v46, v32, v33
v_cvt_pk_bf16_f32 v47, v34, v35
v_mfma_f32_32x32x16_bf16 v[12:27], v[88:91], a[60:63], v[12:27]
s_add_u32 s82, s81, 14336
v_exp_f32 v36, v36
v_exp_f32 v37, v37
v_exp_f32 v38, v38
v_exp_f32 v39, v39
v_cvt_pk_bf16_f32 v48, v36, v37
v_cvt_pk_bf16_f32 v49, v38, v39
v_mfma_f32_32x32x16_bf16 v[100:115], v[76:79], v[44:47], v[100:115]
s_sub_u32 s10, s82, 100352
v_exp_f32 v40, v40
v_exp_f32 v41, v41
v_exp_f32 v42, v42
v_exp_f32 v43, v43
v_cvt_pk_bf16_f32 v50, v40, v41
v_cvt_pk_bf16_f32 v51, v42, v43
v_mfma_f32_32x32x16_bf16 v[28:43], v[84:87], a[64:67], 0
s_load_dwordx2 s[88:89], s[96:97], 0xe3c
buffer_load_dwordx4 v[232:235], v252, s[20:23], s54 offen offset:1024
v_exp_f32 v12, v12
v_exp_f32 v13, v13
v_exp_f32 v14, v14
v_exp_f32 v15, v15
v_cvt_pk_bf16_f32 v44, v12, v13
v_cvt_pk_bf16_f32 v45, v14, v15
v_mfma_f32_32x32x16_bf16 v[100:115], v[80:83], v[48:51], v[100:115]
s_min_u32 s82, s82, s10
v_exp_f32 v16, v16
v_exp_f32 v17, v17
v_exp_f32 v18, v18
v_exp_f32 v19, v19
v_cvt_pk_bf16_f32 v46, v16, v17
v_cvt_pk_bf16_f32 v47, v18, v19
v_mfma_f32_32x32x16_bf16 v[28:43], v[88:91], a[68:71], v[28:43]
s_waitcnt vmcnt(14)
buffer_load_dwordx4 v[76:79], v0, s[16:19], s39 offen offset:2048
v_exp_f32 v20, v20
v_exp_f32 v21, v21
v_exp_f32 v22, v22
v_exp_f32 v23, v23
v_cvt_pk_bf16_f32 v48, v20, v21
v_cvt_pk_bf16_f32 v49, v22, v23
v_mfma_f32_32x32x16_bf16 a[0:15], v[92:95], v[44:47], a[0:15]
s_load_dwordx2 s[88:89], s[98:99], 0x3bc
buffer_load_dwordx4 v[80:83], v0, s[16:19], s39 offen offset:3072
v_exp_f32 v24, v24
v_exp_f32 v25, v25
v_exp_f32 v26, v26
v_exp_f32 v27, v27
v_cvt_pk_bf16_f32 v50, v24, v25
v_cvt_pk_bf16_f32 v51, v26, v27
v_mfma_f32_32x32x16_bf16 v[12:27], v[84:87], a[72:75], 0
s_xor_b32 s39, s53, 0x6000
v_exp_f32 v28, v28
v_exp_f32 v29, v29
v_exp_f32 v30, v30
v_exp_f32 v31, v31
v_cvt_pk_bf16_f32 v44, v28, v29
v_cvt_pk_bf16_f32 v45, v30, v31
v_mfma_f32_32x32x16_bf16 a[0:15], v[96:99], v[48:51], a[0:15]
buffer_load_dwordx4 a[116:119], v252, s[20:23], s54 offen offset:2048
v_exp_f32 v32, v32
v_exp_f32 v33, v33
v_exp_f32 v34, v34
v_exp_f32 v35, v35
v_cvt_pk_bf16_f32 v46, v32, v33
v_cvt_pk_bf16_f32 v47, v34, v35
v_mfma_f32_32x32x16_bf16 v[12:27], v[88:91], a[76:79], v[12:27]
s_add_u32 s83, s82, 14336
v_exp_f32 v36, v36
v_exp_f32 v37, v37
v_exp_f32 v38, v38
v_exp_f32 v39, v39
v_cvt_pk_bf16_f32 v48, v36, v37
v_cvt_pk_bf16_f32 v49, v38, v39
v_mfma_f32_32x32x16_bf16 a[16:31], v[92:95], v[44:47], a[16:31]
buffer_load_dwordx4 a[172:175], v252, s[20:23], s54 offen offset:3072
v_exp_f32 v40, v40
v_exp_f32 v41, v41
v_exp_f32 v42, v42
v_exp_f32 v43, v43
v_cvt_pk_bf16_f32 v50, v40, v41
v_cvt_pk_bf16_f32 v51, v42, v43
v_mfma_f32_32x32x16_bf16 v[28:43], v[84:87], a[48:51], 0
s_sub_u32 s10, s83, 100352
v_exp_f32 v12, v12
v_exp_f32 v13, v13
v_exp_f32 v14, v14
v_exp_f32 v15, v15
v_cvt_pk_bf16_f32 v44, v12, v13
v_cvt_pk_bf16_f32 v45, v14, v15
v_mfma_f32_32x32x16_bf16 a[16:31], v[96:99], v[48:51], a[16:31]
s_load_dwordx2 s[88:89], s[94:95], 0x1c3c
buffer_load_dwordx4 a[228:231], v253, s[20:23], s54 offen offset:0
v_exp_f32 v16, v16
v_exp_f32 v17, v17
v_exp_f32 v18, v18
v_exp_f32 v19, v19
v_cvt_pk_bf16_f32 v46, v16, v17
v_cvt_pk_bf16_f32 v47, v18, v19
v_mfma_f32_32x32x16_bf16 v[28:43], v[88:91], a[52:55], v[28:43]
buffer_load_dwordx4 a[244:247], v253, s[20:23], s54 offen offset:1024
v_exp_f32 v20, v20
v_exp_f32 v21, v21
v_exp_f32 v22, v22
v_exp_f32 v23, v23
v_cvt_pk_bf16_f32 v48, v20, v21
v_cvt_pk_bf16_f32 v49, v22, v23
v_mfma_f32_32x32x16_bf16 a[32:47], v[92:95], v[44:47], a[32:47]
s_waitcnt vmcnt(16)
buffer_load_dwordx4 v[120:123], v2, s[20:23], s54 offen offset:3072
v_exp_f32 v24, v24
v_exp_f32 v25, v25
v_exp_f32 v26, v26
v_exp_f32 v27, v27
v_cvt_pk_bf16_f32 v50, v24, v25
v_cvt_pk_bf16_f32 v51, v26, v27
v_mfma_f32_32x32x16_bf16 v[12:27], v[52:55], a[56:59], 0
buffer_load_dwordx4 v[84:87], v0, s[16:19], s11 offen offset:0
v_exp_f32 v28, v28
v_exp_f32 v29, v29
v_exp_f32 v30, v30
v_exp_f32 v31, v31
v_cvt_pk_bf16_f32 v44, v28, v29
v_cvt_pk_bf16_f32 v45, v30, v31
v_mfma_f32_32x32x16_bf16 a[32:47], v[96:99], v[48:51], a[32:47]
s_load_dwordx2 s[88:89], s[96:97], 0x1c3c
buffer_load_dwordx4 v[88:91], v0, s[16:19], s11 offen offset:1024
v_exp_f32 v32, v32
v_exp_f32 v33, v33
v_exp_f32 v34, v34
v_exp_f32 v35, v35
v_cvt_pk_bf16_f32 v46, v32, v33
v_cvt_pk_bf16_f32 v47, v34, v35
v_mfma_f32_32x32x16_bf16 v[12:27], v[56:59], a[60:63], v[12:27]
s_min_u32 s83, s83, s10
v_exp_f32 v36, v36
v_exp_f32 v37, v37
v_exp_f32 v38, v38
v_exp_f32 v39, v39
v_cvt_pk_bf16_f32 v48, v36, v37
v_cvt_pk_bf16_f32 v49, v38, v39
v_mfma_f32_32x32x16_bf16 v[100:115], v[92:95], v[44:47], v[100:115]
s_add_u32 s40, s83, 14336
v_exp_f32 v40, v40
v_exp_f32 v41, v41
v_exp_f32 v42, v42
v_exp_f32 v43, v43
v_cvt_pk_bf16_f32 v50, v40, v41
v_cvt_pk_bf16_f32 v51, v42, v43
v_mfma_f32_32x32x16_bf16 v[28:43], v[52:55], a[64:67], 0
s_sub_u32 s10, s40, 100352
v_exp_f32 v12, v12
v_exp_f32 v13, v13
v_exp_f32 v14, v14
v_exp_f32 v15, v15
v_cvt_pk_bf16_f32 v44, v12, v13
v_cvt_pk_bf16_f32 v45, v14, v15
v_mfma_f32_32x32x16_bf16 v[100:115], v[96:99], v[48:51], v[100:115]
s_load_dwordx2 s[88:89], s[98:99], 0x73c
buffer_load_dwordx4 v[176:179], v252, s[20:23], s54 offen offset:0
v_exp_f32 v16, v16
v_exp_f32 v17, v17
v_exp_f32 v18, v18
v_exp_f32 v19, v19
v_cvt_pk_bf16_f32 v46, v16, v17
v_cvt_pk_bf16_f32 v47, v18, v19
v_mfma_f32_32x32x16_bf16 v[28:43], v[56:59], a[68:71], v[28:43]
s_waitcnt vmcnt(17)
buffer_load_dwordx4 v[92:95], v0, s[16:19], s11 offen offset:2048
v_exp_f32 v20, v20
v_exp_f32 v21, v21
v_exp_f32 v22, v22
v_exp_f32 v23, v23
v_cvt_pk_bf16_f32 v48, v20, v21
v_cvt_pk_bf16_f32 v49, v22, v23
v_mfma_f32_32x32x16_bf16 a[0:15], v[60:63], v[44:47], a[0:15]
buffer_load_dwordx4 v[96:99], v0, s[16:19], s11 offen offset:3072
v_exp_f32 v24, v24
v_exp_f32 v25, v25
v_exp_f32 v26, v26
v_exp_f32 v27, v27
v_cvt_pk_bf16_f32 v50, v24, v25
v_cvt_pk_bf16_f32 v51, v26, v27
v_mfma_f32_32x32x16_bf16 v[12:27], v[52:55], a[72:75], 0
s_xor_b32 s11, s53, 0x7000
v_exp_f32 v28, v28
v_exp_f32 v29, v29
v_exp_f32 v30, v30
v_exp_f32 v31, v31
v_cvt_pk_bf16_f32 v44, v28, v29
v_cvt_pk_bf16_f32 v45, v30, v31
v_mfma_f32_32x32x16_bf16 a[0:15], v[64:67], v[48:51], a[0:15]
s_min_u32 s40, s40, s10
v_exp_f32 v32, v32
v_exp_f32 v33, v33
v_exp_f32 v34, v34
v_exp_f32 v35, v35
v_cvt_pk_bf16_f32 v46, v32, v33
v_cvt_pk_bf16_f32 v47, v34, v35
v_mfma_f32_32x32x16_bf16 v[12:27], v[56:59], a[76:79], v[12:27]
s_load_dwordx2 s[88:89], s[94:95], 0x2a3c
buffer_load_dwordx4 v[236:239], v0, s[20:23], s80 offen offset:2048
v_exp_f32 v36, v36
v_exp_f32 v37, v37
v_exp_f32 v38, v38
v_exp_f32 v39, v39
v_cvt_pk_bf16_f32 v48, v36, v37
v_cvt_pk_bf16_f32 v49, v38, v39
v_mfma_f32_32x32x16_bf16 a[16:31], v[60:63], v[44:47], a[16:31]
s_add_u32 s51, s40, 14336
v_exp_f32 v40, v40
v_exp_f32 v41, v41
v_exp_f32 v42, v42
v_exp_f32 v43, v43
v_cvt_pk_bf16_f32 v50, v40, v41
v_cvt_pk_bf16_f32 v51, v42, v43
v_mfma_f32_32x32x16_bf16 v[28:43], v[52:55], a[48:51], 0
buffer_load_dwordx4 a[120:123], v0, s[20:23], s80 offen offset:3072
v_exp_f32 v12, v12
v_exp_f32 v13, v13
v_exp_f32 v14, v14
v_exp_f32 v15, v15
v_cvt_pk_bf16_f32 v44, v12, v13
v_cvt_pk_bf16_f32 v45, v14, v15
v_mfma_f32_32x32x16_bf16 a[16:31], v[64:67], v[48:51], a[16:31]
buffer_load_dwordx4 a[176:179], v2, s[20:23], s80 offen offset:0
v_exp_f32 v16, v16
v_exp_f32 v17, v17
v_exp_f32 v18, v18
v_exp_f32 v19, v19
v_cvt_pk_bf16_f32 v46, v16, v17
v_cvt_pk_bf16_f32 v47, v18, v19
v_mfma_f32_32x32x16_bf16 v[28:43], v[56:59], a[52:55], v[28:43]
s_sub_u32 s10, s51, 100352
v_exp_f32 v20, v20
v_exp_f32 v21, v21
v_exp_f32 v22, v22
v_exp_f32 v23, v23
v_cvt_pk_bf16_f32 v48, v20, v21
v_cvt_pk_bf16_f32 v49, v22, v23
v_mfma_f32_32x32x16_bf16 a[32:47], v[60:63], v[44:47], a[32:47]
s_waitcnt vmcnt(16)
buffer_load_dwordx4 a[232:235], v2, s[20:23], s80 offen offset:1024
v_exp_f32 v24, v24
v_exp_f32 v25, v25
v_exp_f32 v26, v26
v_exp_f32 v27, v27
v_cvt_pk_bf16_f32 v50, v24, v25
v_cvt_pk_bf16_f32 v51, v26, v27
v_mfma_f32_32x32x16_bf16 v[12:27], v[68:71], a[56:59], 0
s_load_dwordx2 s[88:89], s[96:97], 0x2a3c
buffer_load_dwordx4 v[52:55], v0, s[16:19], s39 offen offset:0
v_exp_f32 v28, v28
v_exp_f32 v29, v29
v_exp_f32 v30, v30
v_exp_f32 v31, v31
v_cvt_pk_bf16_f32 v44, v28, v29
v_cvt_pk_bf16_f32 v45, v30, v31
v_mfma_f32_32x32x16_bf16 a[32:47], v[64:67], v[48:51], a[32:47]
buffer_load_dwordx4 v[56:59], v0, s[16:19], s39 offen offset:1024
v_exp_f32 v32, v32
v_exp_f32 v33, v33
v_exp_f32 v34, v34
v_exp_f32 v35, v35
v_cvt_pk_bf16_f32 v46, v32, v33
v_cvt_pk_bf16_f32 v47, v34, v35
v_mfma_f32_32x32x16_bf16 v[12:27], v[72:75], a[60:63], v[12:27]
s_min_u32 s51, s51, s10
v_exp_f32 v36, v36
v_exp_f32 v37, v37
v_exp_f32 v38, v38
v_exp_f32 v39, v39
v_cvt_pk_bf16_f32 v48, v36, v37
v_cvt_pk_bf16_f32 v49, v38, v39
v_mfma_f32_32x32x16_bf16 v[100:115], v[60:63], v[44:47], v[100:115]
s_mul_i32 s48, s36, 1792
v_exp_f32 v40, v40
v_exp_f32 v41, v41
v_exp_f32 v42, v42
v_exp_f32 v43, v43
v_cvt_pk_bf16_f32 v50, v40, v41
v_cvt_pk_bf16_f32 v51, v42, v43
v_mfma_f32_32x32x16_bf16 v[28:43], v[68:71], a[64:67], 0
s_load_dwordx2 s[88:89], s[98:99], 0xabc
buffer_load_dwordx4 a[248:251], v2, s[20:23], s80 offen offset:2048
v_exp_f32 v12, v12
v_exp_f32 v13, v13
v_exp_f32 v14, v14
v_exp_f32 v15, v15
v_cvt_pk_bf16_f32 v44, v12, v13
v_cvt_pk_bf16_f32 v45, v14, v15
v_mfma_f32_32x32x16_bf16 v[100:115], v[64:67], v[48:51], v[100:115]
s_add_u32 s59, s84, s48
v_exp_f32 v16, v16
v_exp_f32 v17, v17
v_exp_f32 v18, v18
v_exp_f32 v19, v19
v_cvt_pk_bf16_f32 v46, v16, v17
v_cvt_pk_bf16_f32 v47, v18, v19
v_mfma_f32_32x32x16_bf16 v[28:43], v[72:75], a[68:71], v[28:43]
s_waitcnt vmcnt(17)
buffer_load_dwordx4 v[60:63], v0, s[16:19], s39 offen offset:2048
v_exp_f32 v20, v20
v_exp_f32 v21, v21
v_exp_f32 v22, v22
v_exp_f32 v23, v23
v_cvt_pk_bf16_f32 v48, v20, v21
v_cvt_pk_bf16_f32 v49, v22, v23
v_mfma_f32_32x32x16_bf16 a[0:15], v[76:79], v[44:47], a[0:15]
buffer_load_dwordx4 v[64:67], v0, s[16:19], s39 offen offset:3072
v_exp_f32 v24, v24
v_exp_f32 v25, v25
v_exp_f32 v26, v26
v_exp_f32 v27, v27
v_cvt_pk_bf16_f32 v50, v24, v25
v_cvt_pk_bf16_f32 v51, v26, v27
v_mfma_f32_32x32x16_bf16 v[12:27], v[68:71], a[72:75], 0
s_xor_b32 s39, s53, 0x8000
v_exp_f32 v28, v28
v_exp_f32 v29, v29
v_exp_f32 v30, v30
v_exp_f32 v31, v31
v_cvt_pk_bf16_f32 v44, v28, v29
v_cvt_pk_bf16_f32 v45, v30, v31
v_mfma_f32_32x32x16_bf16 a[0:15], v[80:83], v[48:51], a[0:15]
s_load_dwordx2 s[88:89], s[94:95], 0x383c
buffer_load_dwordx4 v[124:127], v0, s[20:23], s80 offen offset:0
v_exp_f32 v32, v32
v_exp_f32 v33, v33
v_exp_f32 v34, v34
v_exp_f32 v35, v35
v_cvt_pk_bf16_f32 v46, v32, v33
v_cvt_pk_bf16_f32 v47, v34, v35
v_mfma_f32_32x32x16_bf16 v[12:27], v[72:75], a[76:79], v[12:27]
s_sub_u32 s59, s59, 1792
v_exp_f32 v36, v36
v_exp_f32 v37, v37
v_exp_f32 v38, v38
v_exp_f32 v39, v39
v_cvt_pk_bf16_f32 v48, v36, v37
v_cvt_pk_bf16_f32 v49, v38, v39
v_mfma_f32_32x32x16_bf16 a[16:31], v[76:79], v[44:47], a[16:31]
buffer_load_dwordx4 v[180:183], v0, s[20:23], s80 offen offset:1024
v_exp_f32 v40, v40
v_exp_f32 v41, v41
v_exp_f32 v42, v42
v_exp_f32 v43, v43
v_cvt_pk_bf16_f32 v50, v40, v41
v_cvt_pk_bf16_f32 v51, v42, v43
v_mfma_f32_32x32x16_bf16 v[28:43], v[68:71], a[48:51], 0
buffer_load_dwordx4 v[240:243], v252, s[20:23], s80 offen offset:1024
v_exp_f32 v12, v12
v_exp_f32 v13, v13
v_exp_f32 v14, v14
v_exp_f32 v15, v15
v_cvt_pk_bf16_f32 v44, v12, v13
v_cvt_pk_bf16_f32 v45, v14, v15
v_mfma_f32_32x32x16_bf16 a[16:31], v[80:83], v[48:51], a[16:31]
s_add_u32 s52, s50, s48
v_exp_f32 v16, v16
v_exp_f32 v17, v17
v_exp_f32 v18, v18
v_exp_f32 v19, v19
v_cvt_pk_bf16_f32 v46, v16, v17
v_cvt_pk_bf16_f32 v47, v18, v19
v_mfma_f32_32x32x16_bf16 v[28:43], v[72:75], a[52:55], v[28:43]
s_load_dwordx2 s[88:89], s[96:97], 0x383c
buffer_load_dwordx4 a[124:127], v252, s[20:23], s80 offen offset:2048
v_exp_f32 v20, v20
v_exp_f32 v21, v21
v_exp_f32 v22, v22
v_exp_f32 v23, v23
v_cvt_pk_bf16_f32 v48, v20, v21
v_cvt_pk_bf16_f32 v49, v22, v23
v_mfma_f32_32x32x16_bf16 a[32:47], v[76:79], v[44:47], a[32:47]
s_waitcnt vmcnt(16)
buffer_load_dwordx4 a[180:183], v252, s[20:23], s80 offen offset:3072
v_exp_f32 v24, v24
v_exp_f32 v25, v25
v_exp_f32 v26, v26
v_exp_f32 v27, v27
v_cvt_pk_bf16_f32 v50, v24, v25
v_cvt_pk_bf16_f32 v51, v26, v27
v_mfma_f32_32x32x16_bf16 v[12:27], v[84:87], a[56:59], 0
buffer_load_dwordx4 v[68:71], v0, s[16:19], s11 offen offset:0
v_exp_f32 v28, v28
v_exp_f32 v29, v29
v_exp_f32 v30, v30
v_exp_f32 v31, v31
v_cvt_pk_bf16_f32 v44, v28, v29
v_cvt_pk_bf16_f32 v45, v30, v31
v_mfma_f32_32x32x16_bf16 a[32:47], v[80:83], v[48:51], a[32:47]
buffer_load_dwordx4 v[72:75], v0, s[16:19], s11 offen offset:1024
v_exp_f32 v32, v32
v_exp_f32 v33, v33
v_exp_f32 v34, v34
v_exp_f32 v35, v35
v_cvt_pk_bf16_f32 v46, v32, v33
v_cvt_pk_bf16_f32 v47, v34, v35
v_mfma_f32_32x32x16_bf16 v[12:27], v[88:91], a[60:63], v[12:27]
s_add_u32 s49, s50, 3584
v_exp_f32 v36, v36
v_exp_f32 v37, v37
v_exp_f32 v38, v38
v_exp_f32 v39, v39
v_cvt_pk_bf16_f32 v48, v36, v37
v_cvt_pk_bf16_f32 v49, v38, v39
v_mfma_f32_32x32x16_bf16 v[100:115], v[76:79], v[44:47], v[100:115]
s_mul_i32 s44, s36, 3616
v_exp_f32 v40, v40
v_exp_f32 v41, v41
v_exp_f32 v42, v42
v_exp_f32 v43, v43
v_cvt_pk_bf16_f32 v50, v40, v41
v_cvt_pk_bf16_f32 v51, v42, v43
v_mfma_f32_32x32x16_bf16 v[28:43], v[84:87], a[64:67], 0
s_cmp_eq_u32 s36, 3
v_exp_f32 v12, v12
v_exp_f32 v13, v13
v_exp_f32 v14, v14
v_exp_f32 v15, v15
v_cvt_pk_bf16_f32 v44, v12, v13
v_cvt_pk_bf16_f32 v45, v14, v15
v_mfma_f32_32x32x16_bf16 v[100:115], v[80:83], v[48:51], v[100:115]
s_load_dwordx2 s[88:89], s[98:99], 0xe3c
buffer_load_dwordx4 a[236:239], v253, s[20:23], s80 offen offset:0
v_exp_f32 v16, v16
v_exp_f32 v17, v17
v_exp_f32 v18, v18
v_exp_f32 v19, v19
v_cvt_pk_bf16_f32 v46, v16, v17
v_cvt_pk_bf16_f32 v47, v18, v19
v_mfma_f32_32x32x16_bf16 v[28:43], v[88:91], a[68:71], v[28:43]
s_waitcnt vmcnt(17)
buffer_load_dwordx4 v[76:79], v0, s[16:19], s11 offen offset:2048
v_exp_f32 v20, v20
v_exp_f32 v21, v21
v_exp_f32 v22, v22
v_exp_f32 v23, v23
v_cvt_pk_bf16_f32 v48, v20, v21
v_cvt_pk_bf16_f32 v49, v22, v23
v_mfma_f32_32x32x16_bf16 a[0:15], v[92:95], v[44:47], a[0:15]
s_load_dwordx2 s[88:89], s[94:95], 0x463c
buffer_load_dwordx4 v[80:83], v0, s[16:19], s11 offen offset:3072
v_exp_f32 v24, v24
v_exp_f32 v25, v25
v_exp_f32 v26, v26
v_exp_f32 v27, v27
v_cvt_pk_bf16_f32 v50, v24, v25
v_cvt_pk_bf16_f32 v51, v26, v27
v_mfma_f32_32x32x16_bf16 v[12:27], v[84:87], a[72:75], 0
s_cselect_b32 s4, s28, s12
v_exp_f32 v28, v28
v_exp_f32 v29, v29
v_exp_f32 v30, v30
v_exp_f32 v31, v31
v_cvt_pk_bf16_f32 v44, v28, v29
v_cvt_pk_bf16_f32 v45, v30, v31
v_mfma_f32_32x32x16_bf16 a[0:15], v[96:99], v[48:51], a[0:15]
s_cselect_b32 s5, s29, s13
v_exp_f32 v32, v32
v_exp_f32 v33, v33
v_exp_f32 v34, v34
v_exp_f32 v35, v35
v_cvt_pk_bf16_f32 v46, v32, v33
v_cvt_pk_bf16_f32 v47, v34, v35
v_mfma_f32_32x32x16_bf16 v[12:27], v[88:91], a[76:79], v[12:27]
buffer_load_dwordx4 a[252:255], v253, s[20:23], s80 offen offset:1024
v_exp_f32 v36, v36
s_branch L_pf_s4
.p2align 12
L_pf_p4:
L_pf_e0_3:
s_sub_u32 s71, s71, 1
s_cbranch_scc1 L_pf_ret
s_branch L_pf_p6
L_pf_s4:
v_exp_f32 v37, v37
v_exp_f32 v38, v38
v_exp_f32 v39, v39
v_cvt_pk_bf16_f32 v48, v36, v37
v_cvt_pk_bf16_f32 v49, v38, v39
v_mfma_f32_32x32x16_bf16 a[16:31], v[92:95], v[44:47], a[16:31]
s_load_dwordx2 s[88:89], s[96:97], 0x463c
buffer_load_dwordx4 v[128:131], v2, s[20:23], s80 offen offset:3072
v_exp_f32 v40, v40
v_exp_f32 v41, v41
v_exp_f32 v42, v42
v_exp_f32 v43, v43
v_cvt_pk_bf16_f32 v50, v40, v41
v_cvt_pk_bf16_f32 v51, v42, v43
v_mfma_f32_32x32x16_bf16 v[28:43], v[84:87], a[48:51], 0
s_cselect_b32 s6, s30, s14
v_exp_f32 v12, v12
v_exp_f32 v13, v13
v_exp_f32 v14, v14
v_exp_f32 v15, v15
v_cvt_pk_bf16_f32 v44, v12, v13
v_cvt_pk_bf16_f32 v45, v14, v15
v_mfma_f32_32x32x16_bf16 a[16:31], v[96:99], v[48:51], a[16:31]
buffer_load_dwordx4 v[184:187], v252, s[20:23], s80 offen offset:0
v_exp_f32 v16, v16
v_exp_f32 v17, v17
v_exp_f32 v18, v18
v_exp_f32 v19, v19
v_cvt_pk_bf16_f32 v46, v16, v17
v_cvt_pk_bf16_f32 v47, v18, v19
v_mfma_f32_32x32x16_bf16 v[28:43], v[88:91], a[52:55], v[28:43]
s_cselect_b32 s59, s49, s59
v_exp_f32 v20, v20
v_exp_f32 v21, v21
v_exp_f32 v22, v22
v_exp_f32 v23, v23
v_cvt_pk_bf16_f32 v48, v20, v21
v_cvt_pk_bf16_f32 v49, v22, v23
v_mfma_f32_32x32x16_bf16 a[32:47], v[92:95], v[44:47], a[32:47]
s_waitcnt vmcnt(16)
buffer_load_dwordx4 v[244:247], v0, s[20:23], s81 offen offset:2048
v_exp_f32 v24, v24
v_exp_f32 v25, v25
v_exp_f32 v26, v26
v_exp_f32 v27, v27
v_cvt_pk_bf16_f32 v50, v24, v25
v_cvt_pk_bf16_f32 v51, v26, v27
v_mfma_f32_32x32x16_bf16 v[12:27], v[52:55], a[56:59], 0
s_load_dwordx2 s[88:89], s[98:99], 0x11bc
buffer_load_dwordx4 v[84:87], v0, s[16:19], s39 offen offset:0
v_exp_f32 v28, v28
v_exp_f32 v29, v29
v_exp_f32 v30, v30
v_exp_f32 v31, v31
v_cvt_pk_bf16_f32 v44, v28, v29
v_cvt_pk_bf16_f32 v45, v30, v31
v_mfma_f32_32x32x16_bf16 a[32:47], v[96:99], v[48:51], a[32:47]
buffer_load_dwordx4 v[88:91], v0, s[16:19], s39 offen offset:1024
v_exp_f32 v32, v32
v_exp_f32 v33, v33
v_exp_f32 v34, v34
v_exp_f32 v35, v35
v_cvt_pk_bf16_f32 v46, v32, v33
v_cvt_pk_bf16_f32 v47, v34, v35
v_mfma_f32_32x32x16_bf16 v[12:27], v[56:59], a[60:63], v[12:27]
s_xor_b32 s11, s53, 0x9000
v_exp_f32 v36, v36
v_exp_f32 v37, v37
v_exp_f32 v38, v38
v_exp_f32 v39, v39
v_cvt_pk_bf16_f32 v48, v36, v37
v_cvt_pk_bf16_f32 v49, v38, v39
v_mfma_f32_32x32x16_bf16 v[100:115], v[92:95], v[44:47], v[100:115]
s_cmp_eq_u32 s36, 3
v_exp_f32 v40, v40
v_exp_f32 v41, v41
v_exp_f32 v42, v42
v_exp_f32 v43, v43
v_cvt_pk_bf16_f32 v50, v40, v41
v_cvt_pk_bf16_f32 v51, v42, v43
v_mfma_f32_32x32x16_bf16 v[28:43], v[52:55], a[64:67], 0
buffer_load_dwordx4 a[128:131], v0, s[20:23], s81 offen offset:3072
v_exp_f32 v12, v12
v_exp_f32 v13, v13
v_exp_f32 v14, v14
v_exp_f32 v15, v15
v_cvt_pk_bf16_f32 v44, v12, v13
v_cvt_pk_bf16_f32 v45, v14, v15
v_mfma_f32_32x32x16_bf16 v[100:115], v[96:99], v[48:51], v[100:115]
s_load_dwordx2 s[88:89], s[94:95], 0x543c
buffer_load_dwordx4 a[184:187], v2, s[20:23], s81 offen offset:0
v_exp_f32 v16, v16
v_exp_f32 v17, v17
v_exp_f32 v18, v18
v_exp_f32 v19, v19
v_cvt_pk_bf16_f32 v46, v16, v17
v_cvt_pk_bf16_f32 v47, v18, v19
v_mfma_f32_32x32x16_bf16 v[28:43], v[56:59], a[68:71], v[28:43]
s_waitcnt vmcnt(18)
buffer_load_dwordx4 v[92:95], v0, s[16:19], s39 offen offset:2048
v_exp_f32 v20, v20
v_exp_f32 v21, v21
v_exp_f32 v22, v22
v_exp_f32 v23, v23
v_cvt_pk_bf16_f32 v48, v20, v21
v_cvt_pk_bf16_f32 v49, v22, v23
v_mfma_f32_32x32x16_bf16 a[0:15], v[60:63], v[44:47], a[0:15]
buffer_load_dwordx4 v[96:99], v0, s[16:19], s39 offen offset:3072
v_exp_f32 v24, v24
v_exp_f32 v25, v25
v_exp_f32 v26, v26
v_exp_f32 v27, v27
v_cvt_pk_bf16_f32 v50, v24, v25
v_cvt_pk_bf16_f32 v51, v26, v27
v_mfma_f32_32x32x16_bf16 v[12:27], v[52:55], a[72:75], 0
s_cselect_b32 s74, 8128, 0
v_exp_f32 v28, v28
v_exp_f32 v29, v29
v_exp_f32 v30, v30
v_exp_f32 v31, v31
v_cvt_pk_bf16_f32 v44, v28, v29
v_cvt_pk_bf16_f32 v45, v30, v31
v_mfma_f32_32x32x16_bf16 a[0:15], v[64:67], v[48:51], a[0:15]
s_cselect_b32 s43, 0, 1808
v_exp_f32 v32, v32
v_exp_f32 v33, v33
v_exp_f32 v34, v34
v_exp_f32 v35, v35
v_cvt_pk_bf16_f32 v46, v32, v33
v_cvt_pk_bf16_f32 v47, v34, v35
v_mfma_f32_32x32x16_bf16 v[12:27], v[56:59], a[76:79], v[12:27]
s_load_dwordx2 s[88:89], s[96:97], 0x543c
buffer_load_dwordx4 v[132:135], v0, s[20:23], s81 offen offset:0
v_exp_f32 v36, v36
v_exp_f32 v37, v37
v_exp_f32 v38, v38
v_exp_f32 v39, v39
v_cvt_pk_bf16_f32 v48, v36, v37
v_cvt_pk_bf16_f32 v49, v38, v39
v_mfma_f32_32x32x16_bf16 a[16:31], v[60:63], v[44:47], a[16:31]
s_cselect_b32 s48, 0, 1792
v_exp_f32 v40, v40
v_exp_f32 v41, v41
v_exp_f32 v42, v42
v_exp_f32 v43, v43
v_cvt_pk_bf16_f32 v50, v40, v41
v_cvt_pk_bf16_f32 v51, v42, v43
v_mfma_f32_32x32x16_bf16 v[28:43], v[52:55], a[48:51], 0
buffer_load_dwordx4 v[188:191], v0, s[20:23], s81 offen offset:1024
v_exp_f32 v12, v12
v_exp_f32 v13, v13
v_exp_f32 v14, v14
v_exp_f32 v15, v15
v_cvt_pk_bf16_f32 v44, v12, v13
v_cvt_pk_bf16_f32 v45, v14, v15
v_mfma_f32_32x32x16_bf16 a[16:31], v[64:67], v[48:51], a[16:31]
s_cselect_b32 s49, 0, 3616
v_exp_f32 v16, v16
v_exp_f32 v17, v17
v_exp_f32 v18, v18
v_exp_f32 v19, v19
v_cvt_pk_bf16_f32 v46, v16, v17
v_cvt_pk_bf16_f32 v47, v18, v19
v_mfma_f32_32x32x16_bf16 v[28:43], v[56:59], a[52:55], v[28:43]
s_load_dwordx2 s[88:89], s[98:99], 0x153c
buffer_load_dwordx4 v[248:251], v252, s[20:23], s81 offen offset:1024
v_exp_f32 v20, v20
v_exp_f32 v21, v21
v_exp_f32 v22, v22
v_exp_f32 v23, v23
v_cvt_pk_bf16_f32 v48, v20, v21
v_cvt_pk_bf16_f32 v49, v22, v23
v_mfma_f32_32x32x16_bf16 a[32:47], v[60:63], v[44:47], a[32:47]
s_waitcnt vmcnt(16)
buffer_load_dwordx4 a[132:135], v252, s[20:23], s81 offen offset:2048
v_exp_f32 v24, v24
v_exp_f32 v25, v25
v_exp_f32 v26, v26
v_exp_f32 v27, v27
v_cvt_pk_bf16_f32 v50, v24, v25
v_cvt_pk_bf16_f32 v51, v26, v27
v_mfma_f32_32x32x16_bf16 v[12:27], v[68:71], a[56:59], 0
buffer_load_dwordx4 v[52:55], v0, s[16:19], s11 offen offset:0
v_exp_f32 v28, v28
v_exp_f32 v29, v29
v_exp_f32 v30, v30
v_exp_f32 v31, v31
v_cvt_pk_bf16_f32 v44, v28, v29
v_cvt_pk_bf16_f32 v45, v30, v31
v_mfma_f32_32x32x16_bf16 a[32:47], v[64:67], v[48:51], a[32:47]
buffer_load_dwordx4 v[56:59], v0, s[16:19], s11 offen offset:1024
v_exp_f32 v32, v32
v_exp_f32 v33, v33
v_exp_f32 v34, v34
v_exp_f32 v35, v35
v_cvt_pk_bf16_f32 v46, v32, v33
v_cvt_pk_bf16_f32 v47, v34, v35
v_mfma_f32_32x32x16_bf16 v[12:27], v[72:75], a[60:63], v[12:27]
s_cselect_b32 s87, 912, 0
v_exp_f32 v36, v36
v_exp_f32 v37, v37
v_exp_f32 v38, v38
v_exp_f32 v39, v39
v_cvt_pk_bf16_f32 v48, v36, v37
v_cvt_pk_bf16_f32 v49, v38, v39
v_mfma_f32_32x32x16_bf16 v[100:115], v[60:63], v[44:47], v[100:115]
s_xor_b32 s39, s53, 0xa000
v_exp_f32 v40, v40
v_exp_f32 v41, v41
v_exp_f32 v42, v42
v_exp_f32 v43, v43
v_cvt_pk_bf16_f32 v50, v40, v41
v_cvt_pk_bf16_f32 v51, v42, v43
v_mfma_f32_32x32x16_bf16 v[28:43], v[68:71], a[64:67], 0
s_load_dwordx2 s[88:89], s[94:95], 0x623c
buffer_load_dwordx4 a[188:191], v252, s[20:23], s81 offen offset:3072
v_exp_f32 v12, v12
v_exp_f32 v13, v13
v_exp_f32 v14, v14
v_exp_f32 v15, v15
v_cvt_pk_bf16_f32 v44, v12, v13
v_cvt_pk_bf16_f32 v45, v14, v15
v_mfma_f32_32x32x16_bf16 v[100:115], v[64:67], v[48:51], v[100:115]
s_mov_b32 s7, 0x20000
v_exp_f32 v16, v16
v_exp_f32 v17, v17
v_exp_f32 v18, v18
v_exp_f32 v19, v19
v_cvt_pk_bf16_f32 v46, v16, v17
v_cvt_pk_bf16_f32 v47, v18, v19
v_mfma_f32_32x32x16_bf16 v[28:43], v[72:75], a[68:71], v[28:43]
s_waitcnt vmcnt(17)
buffer_load_dwordx4 v[60:63], v0, s[16:19], s11 offen offset:2048
v_exp_f32 v20, v20
v_exp_f32 v21, v21
v_exp_f32 v22, v22
v_exp_f32 v23, v23
v_cvt_pk_bf16_f32 v48, v20, v21
v_cvt_pk_bf16_f32 v49, v22, v23
v_mfma_f32_32x32x16_bf16 a[0:15], v[76:79], v[44:47], a[0:15]
buffer_load_dwordx4 v[64:67], v0, s[16:19], s11 offen offset:3072
v_exp_f32 v24, v24
v_exp_f32 v25, v25
v_exp_f32 v26, v26
v_exp_f32 v27, v27
v_cvt_pk_bf16_f32 v50, v24, v25
v_cvt_pk_bf16_f32 v51, v26, v27
v_mfma_f32_32x32x16_bf16 v[12:27], v[68:71], a[72:75], 0
s_xor_b32 s11, s53, 0xb000
v_exp_f32 v28, v28
v_exp_f32 v29, v29
v_exp_f32 v30, v30
v_exp_f32 v31, v31
v_cvt_pk_bf16_f32 v44, v28, v29
v_cvt_pk_bf16_f32 v45, v30, v31
v_mfma_f32_32x32x16_bf16 a[0:15], v[80:83], v[48:51], a[0:15]
s_load_dwordx2 s[88:89], s[96:97], 0x623c
buffer_load_dwordx4 v[136:139], v2, s[20:23], s81 offen offset:3072
v_exp_f32 v32, v32
v_exp_f32 v33, v33
v_exp_f32 v34, v34
v_exp_f32 v35, v35
v_cvt_pk_bf16_f32 v46, v32, v33
v_cvt_pk_bf16_f32 v47, v34, v35
v_mfma_f32_32x32x16_bf16 v[12:27], v[72:75], a[76:79], v[12:27]
s_add_u32 s87, s87, 896
v_exp_f32 v36, v36
v_exp_f32 v37, v37
v_exp_f32 v38, v38
v_exp_f32 v39, v39
v_cvt_pk_bf16_f32 v48, v36, v37
v_cvt_pk_bf16_f32 v49, v38, v39
v_mfma_f32_32x32x16_bf16 a[16:31], v[76:79], v[44:47], a[16:31]
buffer_load_dwordx4 v[192:195], v252, s[20:23], s81 offen offset:0
v_exp_f32 v40, v40
v_exp_f32 v41, v41
v_exp_f32 v42, v42
v_exp_f32 v43, v43
v_cvt_pk_bf16_f32 v50, v40, v41
v_cvt_pk_bf16_f32 v51, v42, v43
v_mfma_f32_32x32x16_bf16 v[28:43], v[68:71], a[48:51], 0
s_sub_u32 s52, s52, s48
v_exp_f32 v12, v12
v_exp_f32 v13, v13
v_exp_f32 v14, v14
v_exp_f32 v15, v15
v_cvt_pk_bf16_f32 v44, v12, v13
v_cvt_pk_bf16_f32 v45, v14, v15
v_mfma_f32_32x32x16_bf16 a[16:31], v[80:83], v[48:51], a[16:31]
s_load_dwordx2 s[88:89], s[98:99], 0x18bc
buffer_load_dwordx4 a[80:83], v0, s[20:23], s82 offen offset:2048
v_exp_f32 v16, v16
v_exp_f32 v17, v17
v_exp_f32 v18, v18
v_exp_f32 v19, v19
v_cvt_pk_bf16_f32 v46, v16, v17
v_cvt_pk_bf16_f32 v47, v18, v19
v_mfma_f32_32x32x16_bf16 v[28:43], v[72:75], a[52:55], v[28:43]
buffer_load_dwordx4 a[136:139], v0, s[20:23], s82 offen offset:3072
v_exp_f32 v20, v20
v_exp_f32 v21, v21
v_exp_f32 v22, v22
v_exp_f32 v23, v23
v_cvt_pk_bf16_f32 v48, v20, v21
v_cvt_pk_bf16_f32 v49, v22, v23
v_mfma_f32_32x32x16_bf16 a[32:47], v[76:79], v[44:47], a[32:47]
s_waitcnt vmcnt(17)
buffer_load_dwordx4 a[192:195], v2, s[20:23], s82 offen offset:0
v_exp_f32 v24, v24
v_exp_f32 v25, v25
v_exp_f32 v26, v26
v_exp_f32 v27, v27
v_cvt_pk_bf16_f32 v50, v24, v25
v_cvt_pk_bf16_f32 v51, v26, v27
v_mfma_f32_32x32x16_bf16 v[12:27], v[84:87], a[56:59], 0
buffer_load_dwordx4 v[68:71], v0, s[16:19], s39 offen offset:0
v_exp_f32 v28, v28
v_exp_f32 v29, v29
v_exp_f32 v30, v30
v_exp_f32 v31, v31
v_cvt_pk_bf16_f32 v44, v28, v29
v_cvt_pk_bf16_f32 v45, v30, v31
v_mfma_f32_32x32x16_bf16 a[32:47], v[80:83], v[48:51], a[32:47]
s_load_dwordx2 s[88:89], s[94:95], 0x703c
buffer_load_dwordx4 v[72:75], v0, s[16:19], s39 offen offset:1024
v_exp_f32 v32, v32
v_exp_f32 v33, v33
v_exp_f32 v34, v34
v_exp_f32 v35, v35
v_cvt_pk_bf16_f32 v46, v32, v33
v_cvt_pk_bf16_f32 v47, v34, v35
v_mfma_f32_32x32x16_bf16 v[12:27], v[88:91], a[60:63], v[12:27]
s_sub_u32 s44, s44, s49
v_exp_f32 v36, v36
v_exp_f32 v37, v37
v_exp_f32 v38, v38
v_exp_f32 v39, v39
v_cvt_pk_bf16_f32 v48, v36, v37
v_cvt_pk_bf16_f32 v49, v38, v39
v_mfma_f32_32x32x16_bf16 v[100:115], v[76:79], v[44:47], v[100:115]
s_add_u32 s44, s44, 896
v_exp_f32 v40, v40
v_exp_f32 v41, v41
v_exp_f32 v42, v42
v_exp_f32 v43, v43
v_cvt_pk_bf16_f32 v50, v40, v41
v_cvt_pk_bf16_f32 v51, v42, v43
v_mfma_f32_32x32x16_bf16 v[28:43], v[84:87], a[64:67], 0
s_lshl2_add_u32 s84, s36, s84
v_exp_f32 v12, v12
v_exp_f32 v13, v13
v_exp_f32 v14, v14
v_exp_f32 v15, v15
v_cvt_pk_bf16_f32 v44, v12, v13
v_cvt_pk_bf16_f32 v45, v14, v15
v_mfma_f32_32x32x16_bf16 v[100:115], v[80:83], v[48:51], v[100:115]
buffer_load_dwordx4 v[140:143], v0, s[20:23], s82 offen offset:0
v_exp_f32 v16, v16
v_exp_f32 v17, v17
v_exp_f32 v18, v18
v_exp_f32 v19, v19
v_cvt_pk_bf16_f32 v46, v16, v17
v_cvt_pk_bf16_f32 v47, v18, v19
v_mfma_f32_32x32x16_bf16 v[28:43], v[88:91], a[68:71], v[28:43]
s_waitcnt vmcnt(17)
buffer_load_dwordx4 v[76:79], v0, s[16:19], s39 offen offset:2048
v_exp_f32 v20, v20
v_exp_f32 v21, v21
v_exp_f32 v22, v22
v_exp_f32 v23, v23
v_cvt_pk_bf16_f32 v48, v20, v21
v_cvt_pk_bf16_f32 v49, v22, v23
v_mfma_f32_32x32x16_bf16 a[0:15], v[92:95], v[44:47], a[0:15]
s_load_dwordx2 s[88:89], s[96:97], 0x703c
buffer_load_dwordx4 v[80:83], v0, s[16:19], s39 offen offset:3072
v_exp_f32 v24, v24
v_exp_f32 v25, v25
v_exp_f32 v26, v26
v_exp_f32 v27, v27
v_cvt_pk_bf16_f32 v50, v24, v25
v_cvt_pk_bf16_f32 v51, v26, v27
v_mfma_f32_32x32x16_bf16 v[12:27], v[84:87], a[72:75], 0
s_xor_b32 s39, s53, 0xc000
v_exp_f32 v28, v28
v_exp_f32 v29, v29
v_exp_f32 v30, v30
v_exp_f32 v31, v31
v_cvt_pk_bf16_f32 v44, v28, v29
v_cvt_pk_bf16_f32 v45, v30, v31
v_mfma_f32_32x32x16_bf16 a[0:15], v[96:99], v[48:51], a[0:15]
s_cmp_eq_u32 s36, 0
v_exp_f32 v32, v32
v_exp_f32 v33, v33
v_exp_f32 v34, v34
v_exp_f32 v35, v35
v_cvt_pk_bf16_f32 v46, v32, v33
v_cvt_pk_bf16_f32 v47, v34, v35
v_mfma_f32_32x32x16_bf16 v[12:27], v[88:91], a[76:79], v[12:27]
buffer_load_dwordx4 v[196:199], v0, s[20:23], s82 offen offset:1024
v_exp_f32 v36, v36
v_exp_f32 v37, v37
v_exp_f32 v38, v38
v_exp_f32 v39, v39
v_cvt_pk_bf16_f32 v48, v36, v37
v_cvt_pk_bf16_f32 v49, v38, v39
v_mfma_f32_32x32x16_bf16 a[16:31], v[92:95], v[44:47], a[16:31]
s_cselect_b32 s84, 0x10000000, s84
v_exp_f32 v40, v40
v_exp_f32 v41, v41
v_exp_f32 v42, v42
v_exp_f32 v43, v43
v_cvt_pk_bf16_f32 v50, v40, v41
v_cvt_pk_bf16_f32 v51, v42, v43
v_mfma_f32_32x32x16_bf16 v[28:43], v[84:87], a[48:51], 0
s_load_dwordx2 s[88:89], s[98:99], 0x1c3c
buffer_load_dwordx4 a[84:87], v252, s[20:23], s82 offen offset:1024
v_exp_f32 v12, v12
v_exp_f32 v13, v13
v_exp_f32 v14, v14
v_exp_f32 v15, v15
v_cvt_pk_bf16_f32 v44, v12, v13
v_cvt_pk_bf16_f32 v45, v14, v15
v_mfma_f32_32x32x16_bf16 a[16:31], v[96:99], v[48:51], a[16:31]
buffer_load_dwordx4 a[140:143], v252, s[20:23], s82 offen offset:2048
v_exp_f32 v16, v16
v_exp_f32 v17, v17
v_exp_f32 v18, v18
v_exp_f32 v19, v19
v_cvt_pk_bf16_f32 v46, v16, v17
v_cvt_pk_bf16_f32 v47, v18, v19
v_mfma_f32_32x32x16_bf16 v[28:43], v[88:91], a[52:55], v[28:43]
s_cmp_eq_u32 s36, 2
v_exp_f32 v20, v20
v_exp_f32 v21, v21
v_exp_f32 v22, v22
v_exp_f32 v23, v23
v_cvt_pk_bf16_f32 v48, v20, v21
v_cvt_pk_bf16_f32 v49, v22, v23
v_mfma_f32_32x32x16_bf16 a[32:47], v[92:95], v[44:47], a[32:47]
s_waitcnt vmcnt(16)
buffer_load_dwordx4 a[196:199], v252, s[20:23], s82 offen offset:3072
v_exp_f32 v24, v24
v_exp_f32 v25, v25
v_exp_f32 v26, v26
v_exp_f32 v27, v27
v_cvt_pk_bf16_f32 v50, v24, v25
v_cvt_pk_bf16_f32 v51, v26, v27
v_mfma_f32_32x32x16_bf16 v[12:27], v[52:55], a[56:59], 0
s_load_dwordx2 s[88:89], s[94:95], 0x7e3c
buffer_load_dwordx4 v[84:87], v0, s[16:19], s11 offen offset:0
v_exp_f32 v28, v28
v_exp_f32 v29, v29
v_exp_f32 v30, v30
v_exp_f32 v31, v31
v_cvt_pk_bf16_f32 v44, v28, v29
v_cvt_pk_bf16_f32 v45, v30, v31
v_mfma_f32_32x32x16_bf16 a[32:47], v[96:99], v[48:51], a[32:47]
buffer_load_dwordx4 v[88:91], v0, s[16:19], s11 offen offset:1024
v_exp_f32 v32, v32
v_exp_f32 v33, v33
v_exp_f32 v34, v34
v_exp_f32 v35, v35
v_cvt_pk_bf16_f32 v46, v32, v33
v_cvt_pk_bf16_f32 v47, v34, v35
v_mfma_f32_32x32x16_bf16 v[12:27], v[56:59], a[60:63], v[12:27]
s_cselect_b64 s[100:101], -1, 0
v_exp_f32 v36, v36
v_exp_f32 v37, v37
v_exp_f32 v38, v38
v_exp_f32 v39, v39
v_cvt_pk_bf16_f32 v48, v36, v37
v_cvt_pk_bf16_f32 v49, v38, v39
v_mfma_f32_32x32x16_bf16 v[100:115], v[92:95], v[44:47], v[100:115]
s_mov_b32 s79, 2000
v_exp_f32 v40, v40
v_exp_f32 v41, v41
v_exp_f32 v42, v42
v_exp_f32 v43, v43
v_cvt_pk_bf16_f32 v50, v40, v41
v_cvt_pk_bf16_f32 v51, v42, v43
v_mfma_f32_32x32x16_bf16 v[28:43], v[52:55], a[64:67], 0
s_load_dwordx2 s[88:89], s[96:97], 0x7e3c
buffer_load_dwordx4 v[144:147], v2, s[20:23], s82 offen offset:3072
v_exp_f32 v12, v12
v_exp_f32 v13, v13
v_exp_f32 v14, v14
v_exp_f32 v15, v15
v_cvt_pk_bf16_f32 v44, v12, v13
v_cvt_pk_bf16_f32 v45, v14, v15
v_mfma_f32_32x32x16_bf16 v[100:115], v[96:99], v[48:51], v[100:115]
s_lshl_b32 s57, s36, 8
v_exp_f32 v16, v16
v_exp_f32 v17, v17
v_exp_f32 v18, v18
v_exp_f32 v19, v19
v_cvt_pk_bf16_f32 v46, v16, v17
v_cvt_pk_bf16_f32 v47, v18, v19
v_mfma_f32_32x32x16_bf16 v[28:43], v[56:59], a[68:71], v[28:43]
s_waitcnt vmcnt(17)
buffer_load_dwordx4 v[92:95], v0, s[16:19], s11 offen offset:2048
v_exp_f32 v20, v20
v_exp_f32 v21, v21
v_exp_f32 v22, v22
v_exp_f32 v23, v23
v_cvt_pk_bf16_f32 v48, v20, v21
v_cvt_pk_bf16_f32 v49, v22, v23
v_mfma_f32_32x32x16_bf16 a[0:15], v[60:63], v[44:47], a[0:15]
buffer_load_dwordx4 v[96:99], v0, s[16:19], s11 offen offset:3072
v_exp_f32 v24, v24
v_exp_f32 v25, v25
v_exp_f32 v26, v26
v_exp_f32 v27, v27
v_cvt_pk_bf16_f32 v50, v24, v25
v_cvt_pk_bf16_f32 v51, v26, v27
v_mfma_f32_32x32x16_bf16 v[12:27], v[52:55], a[72:75], 0
s_xor_b32 s11, s53, 0xd000
v_exp_f32 v28, v28
v_exp_f32 v29, v29
v_exp_f32 v30, v30
v_exp_f32 v31, v31
v_cvt_pk_bf16_f32 v44, v28, v29
v_cvt_pk_bf16_f32 v45, v30, v31
v_mfma_f32_32x32x16_bf16 a[0:15], v[64:67], v[48:51], a[0:15]
s_load_dwordx2 s[88:89], s[98:99], 0x1fbc
buffer_load_dwordx4 v[200:203], v252, s[20:23], s82 offen offset:0
v_exp_f32 v32, v32
v_exp_f32 v33, v33
v_exp_f32 v34, v34
v_exp_f32 v35, v35
v_cvt_pk_bf16_f32 v46, v32, v33
v_cvt_pk_bf16_f32 v47, v34, v35
v_mfma_f32_32x32x16_bf16 v[12:27], v[56:59], a[76:79], v[12:27]
s_add_u32 s57, s57, 56384
v_exp_f32 v36, v36
v_exp_f32 v37, v37
v_exp_f32 v38, v38
v_exp_f32 v39, v39
v_cvt_pk_bf16_f32 v48, v36, v37
v_cvt_pk_bf16_f32 v49, v38, v39
v_mfma_f32_32x32x16_bf16 a[16:31], v[60:63], v[44:47], a[16:31]
buffer_load_dwordx4 a[88:91], v0, s[20:23], s83 offen offset:2048
v_exp_f32 v40, v40
v_exp_f32 v41, v41
v_exp_f32 v42, v42
v_exp_f32 v43, v43
v_cvt_pk_bf16_f32 v50, v40, v41
v_cvt_pk_bf16_f32 v51, v42, v43
v_mfma_f32_32x32x16_bf16 v[28:43], v[52:55], a[48:51], 0
buffer_load_dwordx4 a[144:147], v0, s[20:23], s83 offen offset:3072
v_exp_f32 v12, v12
v_exp_f32 v13, v13
v_exp_f32 v14, v14
v_exp_f32 v15, v15
v_cvt_pk_bf16_f32 v44, v12, v13
v_cvt_pk_bf16_f32 v45, v14, v15
v_mfma_f32_32x32x16_bf16 a[16:31], v[64:67], v[48:51], a[16:31]
s_sub_u32 s46, s73, 1024
v_exp_f32 v16, v16
v_exp_f32 v17, v17
v_exp_f32 v18, v18
v_exp_f32 v19, v19
v_cvt_pk_bf16_f32 v46, v16, v17
v_cvt_pk_bf16_f32 v47, v18, v19
v_mfma_f32_32x32x16_bf16 v[28:43], v[56:59], a[52:55], v[28:43]
s_load_dwordx2 s[88:89], s[94:95], 0x8c3c
buffer_load_dwordx4 a[200:203], v2, s[20:23], s83 offen offset:0
v_exp_f32 v20, v20
v_exp_f32 v21, v21
v_exp_f32 v22, v22
v_exp_f32 v23, v23
v_cvt_pk_bf16_f32 v48, v20, v21
v_cvt_pk_bf16_f32 v49, v22, v23
v_mfma_f32_32x32x16_bf16 a[32:47], v[60:63], v[44:47], a[32:47]
s_waitcnt vmcnt(16)
buffer_load_dwordx4 v[148:151], v0, s[20:23], s83 offen offset:0
v_exp_f32 v24, v24
v_exp_f32 v25, v25
v_exp_f32 v26, v26
v_exp_f32 v27, v27
v_cvt_pk_bf16_f32 v50, v24, v25
v_cvt_pk_bf16_f32 v51, v26, v27
v_mfma_f32_32x32x16_bf16 v[12:27], v[68:71], a[56:59], 0
buffer_load_dwordx4 v[52:55], v0, s[16:19], s39 offen offset:0
v_exp_f32 v28, v28
v_exp_f32 v29, v29
v_exp_f32 v30, v30
v_exp_f32 v31, v31
v_cvt_pk_bf16_f32 v44, v28, v29
v_cvt_pk_bf16_f32 v45, v30, v31
v_mfma_f32_32x32x16_bf16 a[32:47], v[64:67], v[48:51], a[32:47]
buffer_load_dwordx4 v[56:59], v0, s[16:19], s39 offen offset:1024
v_exp_f32 v32, v32
v_exp_f32 v33, v33
v_exp_f32 v34, v34
v_exp_f32 v35, v35
v_cvt_pk_bf16_f32 v46, v32, v33
v_cvt_pk_bf16_f32 v47, v34, v35
v_mfma_f32_32x32x16_bf16 v[12:27], v[72:75], a[60:63], v[12:27]
s_add_u32 s3, s72, s46
v_exp_f32 v36, v36
v_exp_f32 v37, v37
v_exp_f32 v38, v38
v_exp_f32 v39, v39
v_cvt_pk_bf16_f32 v48, v36, v37
v_cvt_pk_bf16_f32 v49, v38, v39
v_mfma_f32_32x32x16_bf16 v[100:115], v[60:63], v[44:47], v[100:115]
s_add_u32 s8, s3, s46
v_exp_f32 v40, v40
v_exp_f32 v41, v41
v_exp_f32 v42, v42
v_exp_f32 v43, v43
v_cvt_pk_bf16_f32 v50, v40, v41
v_cvt_pk_bf16_f32 v51, v42, v43
v_mfma_f32_32x32x16_bf16 v[28:43], v[68:71], a[64:67], 0
s_add_u32 s9, s8, s46
v_exp_f32 v12, v12
v_exp_f32 v13, v13
v_exp_f32 v14, v14
v_exp_f32 v15, v15
v_cvt_pk_bf16_f32 v44, v12, v13
v_cvt_pk_bf16_f32 v45, v14, v15
v_mfma_f32_32x32x16_bf16 v[100:115], v[64:67], v[48:51], v[100:115]
s_load_dwordx2 s[88:89], s[96:97], 0x8c3c
buffer_load_dwordx4 v[204:207], v0, s[20:23], s83 offen offset:1024
v_exp_f32 v16, v16
v_exp_f32 v17, v17
v_exp_f32 v18, v18
v_exp_f32 v19, v19
v_cvt_pk_bf16_f32 v46, v16, v17
v_cvt_pk_bf16_f32 v47, v18, v19
v_mfma_f32_32x32x16_bf16 v[28:43], v[72:75], a[68:71], v[28:43]
s_waitcnt vmcnt(17)
buffer_load_dwordx4 v[60:63], v0, s[16:19], s39 offen offset:2048
v_exp_f32 v20, v20
v_exp_f32 v21, v21
v_exp_f32 v22, v22
v_exp_f32 v23, v23
v_cvt_pk_bf16_f32 v48, v20, v21
v_cvt_pk_bf16_f32 v49, v22, v23
v_mfma_f32_32x32x16_bf16 a[0:15], v[76:79], v[44:47], a[0:15]
s_load_dwordx2 s[88:89], s[98:99], 0x233c
buffer_load_dwordx4 v[64:67], v0, s[16:19], s39 offen offset:3072
v_exp_f32 v24, v24
v_exp_f32 v25, v25
v_exp_f32 v26, v26
v_exp_f32 v27, v27
v_cvt_pk_bf16_f32 v50, v24, v25
v_cvt_pk_bf16_f32 v51, v26, v27
v_mfma_f32_32x32x16_bf16 v[12:27], v[68:71], a[72:75], 0
s_xor_b32 s39, s53, 0xe000
v_exp_f32 v28, v28
v_exp_f32 v29, v29
v_exp_f32 v30, v30
v_exp_f32 v31, v31
v_cvt_pk_bf16_f32 v44, v28, v29
v_cvt_pk_bf16_f32 v45, v30, v31
v_mfma_f32_32x32x16_bf16 a[0:15], v[80:83], v[48:51], a[0:15]
s_lshl2_add_u32 s60, s73, s72
v_exp_f32 v32, v32
v_exp_f32 v33, v33
v_exp_f32 v34, v34
v_exp_f32 v35, v35
v_cvt_pk_bf16_f32 v46, v32, v33
v_cvt_pk_bf16_f32 v47, v34, v35
v_mfma_f32_32x32x16_bf16 v[12:27], v[72:75], a[76:79], v[12:27]
buffer_load_dwordx4 a[92:95], v252, s[20:23], s83 offen offset:1024
v_exp_f32 v36, v36
v_exp_f32 v37, v37
v_exp_f32 v38, v38
v_exp_f32 v39, v39
v_cvt_pk_bf16_f32 v48, v36, v37
v_cvt_pk_bf16_f32 v49, v38, v39
v_mfma_f32_32x32x16_bf16 a[16:31], v[76:79], v[44:47], a[16:31]
buffer_load_dwordx4 a[148:151], v252, s[20:23], s83 offen offset:2048
v_exp_f32 v40, v40
v_exp_f32 v41, v41
v_exp_f32 v42, v42
v_exp_f32 v43, v43
v_cvt_pk_bf16_f32 v50, v40, v41
v_cvt_pk_bf16_f32 v51, v42, v43
v_mfma_f32_32x32x16_bf16 v[28:43], v[68:71], a[48:51], 0
s_add_u32 s61, s60, s46
v_exp_f32 v12, v12
v_exp_f32 v13, v13
v_exp_f32 v14, v14
v_exp_f32 v15, v15
v_cvt_pk_bf16_f32 v44, v12, v13
v_cvt_pk_bf16_f32 v45, v14, v15
s_branch L_pf_s5
.p2align 12
L_pf_p5:
L_pf_e1_3:
s_sub_u32 s71, s71, 1
s_cbranch_scc1 L_pf_ret
s_branch L_pf_p7
L_pf_s5:
v_mfma_f32_32x32x16_bf16 a[16:31], v[80:83], v[48:51], a[16:31]
s_load_dwordx2 s[88:89], s[94:95], 0x9a3c
buffer_load_dwordx4 a[204:207], v252, s[20:23], s83 offen offset:3072
v_exp_f32 v16, v16
v_exp_f32 v17, v17
v_exp_f32 v18, v18
v_exp_f32 v19, v19
v_cvt_pk_bf16_f32 v46, v16, v17
v_cvt_pk_bf16_f32 v47, v18, v19
v_mfma_f32_32x32x16_bf16 v[28:43], v[72:75], a[52:55], v[28:43]
s_add_u32 s58, s61, s46
v_exp_f32 v20, v20
v_exp_f32 v21, v21
v_exp_f32 v22, v22
v_exp_f32 v23, v23
v_cvt_pk_bf16_f32 v48, v20, v21
v_cvt_pk_bf16_f32 v49, v22, v23
v_mfma_f32_32x32x16_bf16 a[32:47], v[76:79], v[44:47], a[32:47]
s_waitcnt vmcnt(16)
buffer_load_dwordx4 v[152:155], v2, s[20:23], s83 offen offset:3072
v_exp_f32 v24, v24
v_exp_f32 v25, v25
v_exp_f32 v26, v26
v_exp_f32 v27, v27
v_cvt_pk_bf16_f32 v50, v24, v25
v_cvt_pk_bf16_f32 v51, v26, v27
v_mfma_f32_32x32x16_bf16 v[12:27], v[84:87], a[56:59], 0
buffer_load_dwordx4 v[68:71], v0, s[16:19], s11 offen offset:0
v_exp_f32 v28, v28
v_exp_f32 v29, v29
v_exp_f32 v30, v30
v_exp_f32 v31, v31
v_cvt_pk_bf16_f32 v44, v28, v29
v_cvt_pk_bf16_f32 v45, v30, v31
v_mfma_f32_32x32x16_bf16 a[32:47], v[80:83], v[48:51], a[32:47]
s_load_dwordx2 s[88:89], s[96:97], 0x9a3c
buffer_load_dwordx4 v[72:75], v0, s[16:19], s11 offen offset:1024
v_exp_f32 v32, v32
v_exp_f32 v33, v33
v_exp_f32 v34, v34
v_exp_f32 v35, v35
v_cvt_pk_bf16_f32 v46, v32, v33
v_cvt_pk_bf16_f32 v47, v34, v35
v_mfma_f32_32x32x16_bf16 v[12:27], v[88:91], a[60:63], v[12:27]
v_exp_f32 v36, v36
v_exp_f32 v37, v37
v_exp_f32 v38, v38
v_exp_f32 v39, v39
v_cvt_pk_bf16_f32 v48, v36, v37
v_cvt_pk_bf16_f32 v49, v38, v39
v_mfma_f32_32x32x16_bf16 v[100:115], v[76:79], v[44:47], v[100:115]
v_exp_f32 v40, v40
v_exp_f32 v41, v41
v_exp_f32 v42, v42
v_exp_f32 v43, v43
v_cvt_pk_bf16_f32 v50, v40, v41
v_cvt_pk_bf16_f32 v51, v42, v43
v_mfma_f32_32x32x16_bf16 v[28:43], v[84:87], a[64:67], 0
buffer_load_dwordx4 v[208:211], v252, s[20:23], s83 offen offset:0
v_exp_f32 v12, v12
v_exp_f32 v13, v13
v_exp_f32 v14, v14
v_exp_f32 v15, v15
v_cvt_pk_bf16_f32 v44, v12, v13
v_cvt_pk_bf16_f32 v45, v14, v15
v_mfma_f32_32x32x16_bf16 v[100:115], v[80:83], v[48:51], v[100:115]
buffer_load_dwordx4 a[96:99], v0, s[20:23], s40 offen offset:2048
v_exp_f32 v16, v16
v_exp_f32 v17, v17
v_exp_f32 v18, v18
v_exp_f32 v19, v19
v_cvt_pk_bf16_f32 v46, v16, v17
v_cvt_pk_bf16_f32 v47, v18, v19
v_mfma_f32_32x32x16_bf16 v[28:43], v[88:91], a[68:71], v[28:43]
s_waitcnt vmcnt(18)
buffer_load_dwordx4 v[76:79], v0, s[16:19], s11 offen offset:2048
v_exp_f32 v20, v20
v_exp_f32 v21, v21
v_exp_f32 v22, v22
v_exp_f32 v23, v23
v_cvt_pk_bf16_f32 v48, v20, v21
v_cvt_pk_bf16_f32 v49, v22, v23
v_mfma_f32_32x32x16_bf16 a[0:15], v[92:95], v[44:47], a[0:15]
s_load_dwordx2 s[88:89], s[98:99], 0x26bc
buffer_load_dwordx4 v[80:83], v0, s[16:19], s11 offen offset:3072
v_exp_f32 v24, v24
v_exp_f32 v25, v25
v_exp_f32 v26, v26
v_exp_f32 v27, v27
v_cvt_pk_bf16_f32 v50, v24, v25
v_cvt_pk_bf16_f32 v51, v26, v27
v_mfma_f32_32x32x16_bf16 v[12:27], v[84:87], a[72:75], 0
s_xor_b32 s11, s53, 0xf000
v_exp_f32 v28, v28
v_exp_f32 v29, v29
v_exp_f32 v30, v30
v_exp_f32 v31, v31
v_cvt_pk_bf16_f32 v44, v28, v29
v_cvt_pk_bf16_f32 v45, v30, v31
v_mfma_f32_32x32x16_bf16 a[0:15], v[96:99], v[48:51], a[0:15]
v_exp_f32 v32, v32
v_exp_f32 v33, v33
v_exp_f32 v34, v34
v_exp_f32 v35, v35
v_cvt_pk_bf16_f32 v46, v32, v33
v_cvt_pk_bf16_f32 v47, v34, v35
v_mfma_f32_32x32x16_bf16 v[12:27], v[88:91], a[76:79], v[12:27]
s_load_dwordx2 s[88:89], s[94:95], 0xa83c
buffer_load_dwordx4 a[152:155], v0, s[20:23], s40 offen offset:3072
v_exp_f32 v36, v36
v_exp_f32 v37, v37
v_exp_f32 v38, v38
v_exp_f32 v39, v39
v_cvt_pk_bf16_f32 v48, v36, v37
v_cvt_pk_bf16_f32 v49, v38, v39
v_mfma_f32_32x32x16_bf16 a[16:31], v[92:95], v[44:47], a[16:31]
v_exp_f32 v40, v40
v_exp_f32 v41, v41
v_exp_f32 v42, v42
v_exp_f32 v43, v43
v_cvt_pk_bf16_f32 v50, v40, v41
v_cvt_pk_bf16_f32 v51, v42, v43
v_mfma_f32_32x32x16_bf16 v[28:43], v[84:87], a[48:51], 0
buffer_load_dwordx4 a[208:211], v2, s[20:23], s40 offen offset:0
v_exp_f32 v12, v12
v_exp_f32 v13, v13
v_exp_f32 v14, v14
v_exp_f32 v15, v15
v_cvt_pk_bf16_f32 v44, v12, v13
v_cvt_pk_bf16_f32 v45, v14, v15
v_mfma_f32_32x32x16_bf16 a[16:31], v[96:99], v[48:51], a[16:31]
v_exp_f32 v16, v16
v_exp_f32 v17, v17
v_exp_f32 v18, v18
v_exp_f32 v19, v19
v_cvt_pk_bf16_f32 v46, v16, v17
v_cvt_pk_bf16_f32 v47, v18, v19
v_mfma_f32_32x32x16_bf16 v[28:43], v[88:91], a[52:55], v[28:43]
buffer_load_dwordx4 v[156:159], v0, s[20:23], s40 offen offset:0
v_exp_f32 v20, v20
v_exp_f32 v21, v21
v_exp_f32 v22, v22
v_exp_f32 v23, v23
v_cvt_pk_bf16_f32 v48, v20, v21
v_cvt_pk_bf16_f32 v49, v22, v23
v_mfma_f32_32x32x16_bf16 a[32:47], v[92:95], v[44:47], a[32:47]
s_waitcnt vmcnt(16)
buffer_load_dwordx4 v[212:215], v0, s[20:23], s40 offen offset:1024
v_exp_f32 v24, v24
v_exp_f32 v25, v25
v_exp_f32 v26, v26
v_exp_f32 v27, v27
v_cvt_pk_bf16_f32 v50, v24, v25
v_cvt_pk_bf16_f32 v51, v26, v27
v_mfma_f32_32x32x16_bf16 v[12:27], v[52:55], a[56:59], 0
s_load_dwordx2 s[88:89], s[96:97], 0xa83c
buffer_load_dwordx4 v[84:87], v0, s[16:19], s39 offen offset:0
v_exp_f32 v28, v28
v_exp_f32 v29, v29
v_exp_f32 v30, v30
v_exp_f32 v31, v31
v_cvt_pk_bf16_f32 v44, v28, v29
v_cvt_pk_bf16_f32 v45, v30, v31
v_mfma_f32_32x32x16_bf16 a[32:47], v[96:99], v[48:51], a[32:47]
buffer_load_dwordx4 v[88:91], v0, s[16:19], s39 offen offset:1024
v_exp_f32 v32, v32
v_exp_f32 v33, v33
v_exp_f32 v34, v34
v_exp_f32 v35, v35
v_cvt_pk_bf16_f32 v46, v32, v33
v_cvt_pk_bf16_f32 v47, v34, v35
v_mfma_f32_32x32x16_bf16 v[12:27], v[56:59], a[60:63], v[12:27]
v_exp_f32 v36, v36
v_exp_f32 v37, v37
v_exp_f32 v38, v38
v_exp_f32 v39, v39
v_cvt_pk_bf16_f32 v48, v36, v37
v_cvt_pk_bf16_f32 v49, v38, v39
v_mfma_f32_32x32x16_bf16 v[100:115], v[92:95], v[44:47], v[100:115]
v_exp_f32 v40, v40
v_exp_f32 v41, v41
v_exp_f32 v42, v42
v_exp_f32 v43, v43
v_cvt_pk_bf16_f32 v50, v40, v41
v_cvt_pk_bf16_f32 v51, v42, v43
v_mfma_f32_32x32x16_bf16 v[28:43], v[52:55], a[64:67], 0
s_load_dwordx2 s[88:89], s[98:99], 0x2a3c
buffer_load_dwordx4 a[100:103], v252, s[20:23], s40 offen offset:1024
v_exp_f32 v12, v12
v_exp_f32 v13, v13
v_exp_f32 v14, v14
v_exp_f32 v15, v15
v_cvt_pk_bf16_f32 v44, v12, v13
v_cvt_pk_bf16_f32 v45, v14, v15
v_mfma_f32_32x32x16_bf16 v[100:115], v[96:99], v[48:51], v[100:115]
v_exp_f32 v16, v16
v_exp_f32 v17, v17
v_exp_f32 v18, v18
v_exp_f32 v19, v19
v_cvt_pk_bf16_f32 v46, v16, v17
v_cvt_pk_bf16_f32 v47, v18, v19
v_mfma_f32_32x32x16_bf16 v[28:43], v[56:59], a[68:71], v[28:43]
s_waitcnt vmcnt(17)
buffer_load_dwordx4 v[92:95], v0, s[16:19], s39 offen offset:2048
v_exp_f32 v20, v20
v_exp_f32 v21, v21
v_exp_f32 v22, v22
v_exp_f32 v23, v23
v_cvt_pk_bf16_f32 v48, v20, v21
v_cvt_pk_bf16_f32 v49, v22, v23
v_mfma_f32_32x32x16_bf16 a[0:15], v[60:63], v[44:47], a[0:15]
buffer_load_dwordx4 v[96:99], v0, s[16:19], s39 offen offset:3072
v_exp_f32 v24, v24
v_exp_f32 v25, v25
v_exp_f32 v26, v26
v_exp_f32 v27, v27
v_cvt_pk_bf16_f32 v50, v24, v25
v_cvt_pk_bf16_f32 v51, v26, v27
v_mfma_f32_32x32x16_bf16 v[12:27], v[52:55], a[72:75], 0
v_exp_f32 v28, v28
v_exp_f32 v29, v29
v_exp_f32 v30, v30
v_exp_f32 v31, v31
v_cvt_pk_bf16_f32 v44, v28, v29
v_cvt_pk_bf16_f32 v45, v30, v31
v_mfma_f32_32x32x16_bf16 a[0:15], v[64:67], v[48:51], a[0:15]
s_load_dwordx2 s[88:89], s[94:95], 0xb63c
buffer_load_dwordx4 a[156:159], v252, s[20:23], s40 offen offset:2048
v_exp_f32 v32, v32
v_exp_f32 v33, v33
v_exp_f32 v34, v34
v_exp_f32 v35, v35
v_cvt_pk_bf16_f32 v46, v32, v33
v_cvt_pk_bf16_f32 v47, v34, v35
v_mfma_f32_32x32x16_bf16 v[12:27], v[56:59], a[76:79], v[12:27]
s_mov_b32 m0, s78
v_exp_f32 v36, v36
v_exp_f32 v37, v37
v_exp_f32 v38, v38
v_exp_f32 v39, v39
v_cvt_pk_bf16_f32 v48, v36, v37
v_cvt_pk_bf16_f32 v49, v38, v39
v_mfma_f32_32x32x16_bf16 a[16:31], v[60:63], v[44:47], a[16:31]
buffer_load_dwordx4 a[212:215], v252, s[20:23], s40 offen offset:3072
v_exp_f32 v40, v40
v_exp_f32 v41, v41
v_exp_f32 v42, v42
v_exp_f32 v43, v43
v_cvt_pk_bf16_f32 v50, v40, v41
v_cvt_pk_bf16_f32 v51, v42, v43
v_mfma_f32_32x32x16_bf16 v[28:43], v[52:55], a[48:51], 0
buffer_load_dwordx4 v224, s[24:27], s55 offen lds
v_exp_f32 v12, v12
v_exp_f32 v13, v13
v_exp_f32 v14, v14
v_exp_f32 v15, v15
v_cvt_pk_bf16_f32 v44, v12, v13
v_cvt_pk_bf16_f32 v45, v14, v15
v_mfma_f32_32x32x16_bf16 a[16:31], v[64:67], v[48:51], a[16:31]
s_sub_u32 m0, s78, 2560
v_exp_f32 v16, v16
v_exp_f32 v17, v17
v_exp_f32 v18, v18
v_exp_f32 v19, v19
v_cvt_pk_bf16_f32 v46, v16, v17
v_cvt_pk_bf16_f32 v47, v18, v19
v_mfma_f32_32x32x16_bf16 v[28:43], v[56:59], a[52:55], v[28:43]
s_load_dwordx2 s[88:89], s[96:97], 0xb63c
buffer_load_dwordx4 v224, s[24:27], s55 offen offset:3584 lds
v_exp_f32 v20, v20
v_exp_f32 v21, v21
v_exp_f32 v22, v22
v_exp_f32 v23, v23
v_cvt_pk_bf16_f32 v48, v20, v21
v_cvt_pk_bf16_f32 v49, v22, v23
v_mfma_f32_32x32x16_bf16 a[32:47], v[60:63], v[44:47], a[32:47]
s_waitcnt vmcnt(17)
buffer_load_dwordx4 v[160:163], v2, s[20:23], s40 offen offset:3072
v_exp_f32 v24, v24
v_exp_f32 v25, v25
v_exp_f32 v26, v26
v_exp_f32 v27, v27
v_cvt_pk_bf16_f32 v50, v24, v25
v_cvt_pk_bf16_f32 v51, v26, v27
v_mfma_f32_32x32x16_bf16 v[12:27], v[68:71], a[56:59], 0
buffer_load_dwordx4 v[52:55], v0, s[16:19], s11 offen offset:0
v_exp_f32 v28, v28
v_exp_f32 v29, v29
v_exp_f32 v30, v30
v_exp_f32 v31, v31
v_cvt_pk_bf16_f32 v44, v28, v29
v_cvt_pk_bf16_f32 v45, v30, v31
v_mfma_f32_32x32x16_bf16 a[32:47], v[64:67], v[48:51], a[32:47]
buffer_load_dwordx4 v[56:59], v0, s[16:19], s11 offen offset:1024
v_exp_f32 v32, v32
v_exp_f32 v33, v33
v_exp_f32 v34, v34
v_exp_f32 v35, v35
v_cvt_pk_bf16_f32 v46, v32, v33
v_cvt_pk_bf16_f32 v47, v34, v35
v_mfma_f32_32x32x16_bf16 v[12:27], v[72:75], a[60:63], v[12:27]
s_add_u32 m0, s78, 2048
v_exp_f32 v36, v36
v_exp_f32 v37, v37
v_exp_f32 v38, v38
v_exp_f32 v39, v39
v_cvt_pk_bf16_f32 v48, v36, v37
v_cvt_pk_bf16_f32 v49, v38, v39
v_mfma_f32_32x32x16_bf16 v[100:115], v[60:63], v[44:47], v[100:115]
s_load_dwordx2 s[88:89], s[98:99], 0x2dbc
buffer_load_dwordx4 v0, s[32:35], s56 offen lds
v_exp_f32 v40, v40
v_exp_f32 v41, v41
v_exp_f32 v42, v42
v_exp_f32 v43, v43
v_cvt_pk_bf16_f32 v50, v40, v41
v_cvt_pk_bf16_f32 v51, v42, v43
v_mfma_f32_32x32x16_bf16 v[28:43], v[68:71], a[64:67], 0
v_exp_f32 v12, v12
v_exp_f32 v13, v13
v_exp_f32 v14, v14
v_exp_f32 v15, v15
v_cvt_pk_bf16_f32 v44, v12, v13
v_cvt_pk_bf16_f32 v45, v14, v15
v_mfma_f32_32x32x16_bf16 v[100:115], v[64:67], v[48:51], v[100:115]
v_exp_f32 v16, v16
v_exp_f32 v17, v17
v_exp_f32 v18, v18
v_exp_f32 v19, v19
v_cvt_pk_bf16_f32 v46, v16, v17
v_cvt_pk_bf16_f32 v47, v18, v19
v_mfma_f32_32x32x16_bf16 v[28:43], v[72:75], a[68:71], v[28:43]
s_waitcnt vmcnt(17)
buffer_load_dwordx4 v[60:63], v0, s[16:19], s11 offen offset:2048
v_exp_f32 v20, v20
v_exp_f32 v21, v21
v_exp_f32 v22, v22
v_exp_f32 v23, v23
v_cvt_pk_bf16_f32 v48, v20, v21
v_cvt_pk_bf16_f32 v49, v22, v23
v_mfma_f32_32x32x16_bf16 a[0:15], v[76:79], v[44:47], a[0:15]
buffer_load_dwordx4 v[64:67], v0, s[16:19], s11 offen offset:3072
v_exp_f32 v24, v24
v_exp_f32 v25, v25
v_exp_f32 v26, v26
v_exp_f32 v27, v27
v_cvt_pk_bf16_f32 v50, v24, v25
v_cvt_pk_bf16_f32 v51, v26, v27
v_mfma_f32_32x32x16_bf16 v[12:27], v[68:71], a[72:75], 0
v_exp_f32 v28, v28
v_exp_f32 v29, v29
v_exp_f32 v30, v30
v_exp_f32 v31, v31
v_cvt_pk_bf16_f32 v44, v28, v29
v_cvt_pk_bf16_f32 v45, v30, v31
v_mfma_f32_32x32x16_bf16 a[0:15], v[80:83], v[48:51], a[0:15]
v_exp_f32 v32, v32
v_exp_f32 v33, v33
v_exp_f32 v34, v34
v_exp_f32 v35, v35
v_cvt_pk_bf16_f32 v46, v32, v33
v_cvt_pk_bf16_f32 v47, v34, v35
v_mfma_f32_32x32x16_bf16 v[12:27], v[72:75], a[76:79], v[12:27]
buffer_load_dwordx4 v[216:219], v252, s[20:23], s40 offen offset:0
v_exp_f32 v36, v36
v_exp_f32 v37, v37
v_exp_f32 v38, v38
v_exp_f32 v39, v39
v_cvt_pk_bf16_f32 v48, v36, v37
v_cvt_pk_bf16_f32 v49, v38, v39
v_mfma_f32_32x32x16_bf16 a[16:31], v[76:79], v[44:47], a[16:31]
s_waitcnt vmcnt(14)
buffer_load_dwordx4 a[104:107], v0, s[20:23], s51 offen offset:2048
v_exp_f32 v40, v40
v_exp_f32 v41, v41
v_exp_f32 v42, v42
v_exp_f32 v43, v43
v_cvt_pk_bf16_f32 v50, v40, v41
v_cvt_pk_bf16_f32 v51, v42, v43
v_mfma_f32_32x32x16_bf16 v[28:43], v[84:87], a[56:59], 0
v_exp_f32 v12, v12
v_exp_f32 v13, v13
v_exp_f32 v14, v14
v_exp_f32 v15, v15
v_cvt_pk_bf16_f32 v44, v12, v13
v_cvt_pk_bf16_f32 v45, v14, v15
v_mfma_f32_32x32x16_bf16 a[16:31], v[80:83], v[48:51], a[16:31]
buffer_load_dwordx4 a[160:163], v0, s[20:23], s51 offen offset:3072
v_exp_f32 v16, v16
v_exp_f32 v17, v17
v_exp_f32 v18, v18
v_exp_f32 v19, v19
v_cvt_pk_bf16_f32 v46, v16, v17
v_cvt_pk_bf16_f32 v47, v18, v19
v_mfma_f32_32x32x16_bf16 v[28:43], v[88:91], a[60:63], v[28:43]
v_exp_f32 v20, v20
v_exp_f32 v21, v21
v_exp_f32 v22, v22
v_exp_f32 v23, v23
v_cvt_pk_bf16_f32 v48, v20, v21
v_cvt_pk_bf16_f32 v49, v22, v23
v_mfma_f32_32x32x16_bf16 a[32:47], v[76:79], v[44:47], a[32:47]
buffer_load_dwordx4 a[216:219], v2, s[20:23], s51 offen offset:0
v_exp_f32 v24, v24
v_exp_f32 v25, v25
v_exp_f32 v26, v26
v_exp_f32 v27, v27
v_cvt_pk_bf16_f32 v50, v24, v25
v_cvt_pk_bf16_f32 v51, v26, v27
v_mfma_f32_32x32x16_bf16 v[12:27], v[84:87], a[64:67], 0
v_exp_f32 v28, v28
v_exp_f32 v29, v29
v_exp_f32 v30, v30
v_exp_f32 v31, v31
v_cvt_pk_bf16_f32 v44, v28, v29
v_cvt_pk_bf16_f32 v45, v30, v31
v_mfma_f32_32x32x16_bf16 a[32:47], v[80:83], v[48:51], a[32:47]
buffer_load_dwordx4 v[164:167], v0, s[20:23], s51 offen offset:0
v_exp_f32 v32, v32
v_exp_f32 v33, v33
v_exp_f32 v34, v34
v_exp_f32 v35, v35
v_cvt_pk_bf16_f32 v46, v32, v33
v_cvt_pk_bf16_f32 v47, v34, v35
v_mfma_f32_32x32x16_bf16 v[12:27], v[88:91], a[68:71], v[12:27]
s_waitcnt vmcnt(15)
buffer_load_dwordx4 v[220:223], v0, s[20:23], s51 offen offset:1024
v_exp_f32 v36, v36
v_exp_f32 v37, v37
v_exp_f32 v38, v38
v_exp_f32 v39, v39
v_cvt_pk_bf16_f32 v48, v36, v37
v_cvt_pk_bf16_f32 v49, v38, v39
v_mfma_f32_32x32x16_bf16 a[0:15], v[92:95], v[44:47], a[0:15]
v_exp_f32 v40, v40
v_exp_f32 v41, v41
v_exp_f32 v42, v42
v_exp_f32 v43, v43
v_cvt_pk_bf16_f32 v50, v40, v41
v_cvt_pk_bf16_f32 v51, v42, v43
v_mfma_f32_32x32x16_bf16 v[28:43], v[84:87], a[72:75], 0
buffer_load_dwordx4 a[108:111], v252, s[20:23], s51 offen offset:1024
v_exp_f32 v12, v12
v_exp_f32 v13, v13
v_exp_f32 v14, v14
v_exp_f32 v15, v15
v_cvt_pk_bf16_f32 v44, v12, v13
v_cvt_pk_bf16_f32 v45, v14, v15
v_mfma_f32_32x32x16_bf16 a[0:15], v[96:99], v[48:51], a[0:15]
v_exp_f32 v16, v16
v_exp_f32 v17, v17
v_exp_f32 v18, v18
v_exp_f32 v19, v19
v_cvt_pk_bf16_f32 v46, v16, v17
v_cvt_pk_bf16_f32 v47, v18, v19
v_mfma_f32_32x32x16_bf16 v[28:43], v[88:91], a[76:79], v[28:43]
buffer_load_dwordx4 a[164:167], v252, s[20:23], s51 offen offset:2048
v_exp_f32 v20, v20
v_exp_f32 v21, v21
v_exp_f32 v22, v22
v_exp_f32 v23, v23
v_cvt_pk_bf16_f32 v48, v20, v21
v_cvt_pk_bf16_f32 v49, v22, v23
v_mfma_f32_32x32x16_bf16 a[16:31], v[92:95], v[44:47], a[16:31]
s_waitcnt vmcnt(11)
buffer_load_dwordx4 a[220:223], v252, s[20:23], s51 offen offset:3072
v_exp_f32 v24, v24
v_exp_f32 v25, v25
v_exp_f32 v26, v26
v_exp_f32 v27, v27
v_cvt_pk_bf16_f32 v50, v24, v25
v_cvt_pk_bf16_f32 v51, v26, v27
v_mfma_f32_32x32x16_bf16 v[12:27], v[52:55], a[56:59], 0
v_exp_f32 v28, v28
v_exp_f32 v29, v29
v_exp_f32 v30, v30
v_exp_f32 v31, v31
v_cvt_pk_bf16_f32 v44, v28, v29
v_cvt_pk_bf16_f32 v45, v30, v31
v_mfma_f32_32x32x16_bf16 a[16:31], v[96:99], v[48:51], a[16:31]
buffer_load_dwordx4 v[168:171], v2, s[20:23], s51 offen offset:3072
v_exp_f32 v32, v32
v_exp_f32 v33, v33
v_exp_f32 v34, v34
v_exp_f32 v35, v35
v_cvt_pk_bf16_f32 v46, v32, v33
v_cvt_pk_bf16_f32 v47, v34, v35
v_mfma_f32_32x32x16_bf16 v[12:27], v[56:59], a[60:63], v[12:27]
v_exp_f32 v36, v36
v_exp_f32 v37, v37
v_exp_f32 v38, v38
v_exp_f32 v39, v39
v_cvt_pk_bf16_f32 v48, v36, v37
v_cvt_pk_bf16_f32 v49, v38, v39
v_mfma_f32_32x32x16_bf16 a[32:47], v[92:95], v[44:47], a[32:47]
buffer_load_dwordx4 v[224:227], v252, s[20:23], s51 offen offset:0
v_exp_f32 v40, v40
v_exp_f32 v41, v41
v_exp_f32 v42, v42
v_exp_f32 v43, v43
v_cvt_pk_bf16_f32 v50, v40, v41
v_cvt_pk_bf16_f32 v51, v42, v43
v_mfma_f32_32x32x16_bf16 v[28:43], v[52:55], a[64:67], 0
buffer_load_dwordx4 a[56:59], v2, s[20:23], s81 offen offset:1024
v_exp_f32 v12, v12
v_exp_f32 v13, v13
v_exp_f32 v14, v14
v_exp_f32 v15, v15
v_cvt_pk_bf16_f32 v44, v12, v13
v_cvt_pk_bf16_f32 v45, v14, v15
v_mfma_f32_32x32x16_bf16 a[32:47], v[96:99], v[48:51], a[32:47]
buffer_load_dwordx4 a[60:63], v253, s[20:23], s81 offen offset:0
v_exp_f32 v16, v16
v_exp_f32 v17, v17
v_exp_f32 v18, v18
v_exp_f32 v19, v19
v_cvt_pk_bf16_f32 v46, v16, v17
v_cvt_pk_bf16_f32 v47, v18, v19
v_mfma_f32_32x32x16_bf16 v[28:43], v[56:59], a[68:71], v[28:43]
s_waitcnt vmcnt(13)
v_exp_f32 v20, v20
v_exp_f32 v21, v21
v_exp_f32 v22, v22
v_exp_f32 v23, v23
v_cvt_pk_bf16_f32 v48, v20, v21
v_cvt_pk_bf16_f32 v49, v22, v23
v_mfma_f32_32x32x16_bf16 a[0:15], v[60:63], v[44:47], a[0:15]
v_exp_f32 v24, v24
v_exp_f32 v25, v25
v_exp_f32 v26, v26
v_exp_f32 v27, v27
v_cvt_pk_bf16_f32 v50, v24, v25
v_cvt_pk_bf16_f32 v51, v26, v27
v_mfma_f32_32x32x16_bf16 v[12:27], v[52:55], a[72:75], 0
buffer_load_dwordx4 a[64:67], v2, s[20:23], s82 offen offset:1024
v_exp_f32 v28, v28
v_exp_f32 v29, v29
v_exp_f32 v30, v30
v_exp_f32 v31, v31
v_cvt_pk_bf16_f32 v44, v28, v29
v_cvt_pk_bf16_f32 v45, v30, v31
v_mfma_f32_32x32x16_bf16 a[0:15], v[64:67], v[48:51], a[0:15]
buffer_load_dwordx4 a[68:71], v253, s[20:23], s82 offen offset:0
v_exp_f32 v32, v32
v_exp_f32 v33, v33
v_exp_f32 v34, v34
v_exp_f32 v35, v35
v_cvt_pk_bf16_f32 v46, v32, v33
v_cvt_pk_bf16_f32 v47, v34, v35
v_mfma_f32_32x32x16_bf16 v[12:27], v[56:59], a[76:79], v[12:27]
v_exp_f32 v36, v36
v_exp_f32 v37, v37
v_exp_f32 v38, v38
v_exp_f32 v39, v39
v_cvt_pk_bf16_f32 v48, v36, v37
v_cvt_pk_bf16_f32 v49, v38, v39
v_mfma_f32_32x32x16_bf16 a[16:31], v[60:63], v[44:47], a[16:31]
ds_write_b128 v8, a[0:3] offset:0
ds_write_b128 v8, a[4:7] offset:1024
v_exp_f32 v40, v40
v_exp_f32 v41, v41
v_exp_f32 v42, v42
v_exp_f32 v43, v43
v_cvt_pk_bf16_f32 v50, v40, v41
v_cvt_pk_bf16_f32 v51, v42, v43
v_mfma_f32_32x32x16_bf16 v[28:43], v[68:71], a[48:51], 0
ds_write_b128 v8, a[8:11] offset:2048
ds_write_b128 v8, a[12:15] offset:3072
buffer_load_dwordx4 a[72:75], v2, s[20:23], s83 offen offset:1024
v_exp_f32 v12, v12
v_exp_f32 v13, v13
v_exp_f32 v14, v14
v_exp_f32 v15, v15
v_cvt_pk_bf16_f32 v44, v12, v13
v_cvt_pk_bf16_f32 v45, v14, v15
v_mfma_f32_32x32x16_bf16 a[16:31], v[64:67], v[48:51], a[16:31]
buffer_load_dwordx4 a[76:79], v253, s[20:23], s83 offen offset:0
v_exp_f32 v16, v16
v_exp_f32 v17, v17
v_exp_f32 v18, v18
v_exp_f32 v19, v19
v_cvt_pk_bf16_f32 v46, v16, v17
v_cvt_pk_bf16_f32 v47, v18, v19
v_mfma_f32_32x32x16_bf16 v[28:43], v[72:75], a[52:55], v[28:43]
buffer_load_dwordx4 a[0:3], v2, s[20:23], s40 offen offset:1024
v_exp_f32 v20, v20
v_exp_f32 v21, v21
v_exp_f32 v22, v22
v_exp_f32 v23, v23
v_cvt_pk_bf16_f32 v48, v20, v21
v_cvt_pk_bf16_f32 v49, v22, v23
v_mfma_f32_32x32x16_bf16 a[32:47], v[60:63], v[44:47], a[32:47]
ds_write_b128 v9, a[16:19] offset:0
ds_write_b128 v9, a[20:23] offset:1024
buffer_load_dwordx4 a[4:7], v253, s[20:23], s40 offen offset:0
v_exp_f32 v24, v24
v_exp_f32 v25, v25
v_exp_f32 v26, v26
v_exp_f32 v27, v27
v_cvt_pk_bf16_f32 v50, v24, v25
v_cvt_pk_bf16_f32 v51, v26, v27
v_mfma_f32_32x32x16_bf16 v[12:27], v[84:87], a[48:51], 0
ds_write_b128 v9, a[24:27] offset:2048
ds_write_b128 v9, a[28:31] offset:3072
buffer_load_dwordx4 a[8:11], v2, s[20:23], s51 offen offset:1024
v_exp_f32 v28, v28
v_exp_f32 v29, v29
v_exp_f32 v30, v30
v_exp_f32 v31, v31
v_cvt_pk_bf16_f32 v44, v28, v29
v_cvt_pk_bf16_f32 v45, v30, v31
v_mfma_f32_32x32x16_bf16 a[32:47], v[64:67], v[48:51], a[32:47]
buffer_load_dwordx4 a[12:15], v253, s[20:23], s51 offen offset:0
v_exp_f32 v32, v32
v_exp_f32 v33, v33
v_exp_f32 v34, v34
v_exp_f32 v35, v35
v_cvt_pk_bf16_f32 v46, v32, v33
v_cvt_pk_bf16_f32 v47, v34, v35
v_mfma_f32_32x32x16_bf16 v[12:27], v[88:91], a[52:55], v[12:27]
buffer_load_dwordx4 a[16:19], v2, s[20:23], s81 offen offset:2048
v_exp_f32 v36, v36
v_exp_f32 v37, v37
v_exp_f32 v38, v38
v_exp_f32 v39, v39
v_cvt_pk_bf16_f32 v48, v36, v37
v_cvt_pk_bf16_f32 v49, v38, v39
v_mfma_f32_32x32x16_bf16 v[100:115], v[76:79], v[44:47], v[100:115]
ds_write_b128 v10, a[32:35] offset:0
ds_write_b128 v10, a[36:39] offset:1024
buffer_load_dwordx4 a[20:23], v253, s[20:23], s81 offen offset:1024
v_exp_f32 v40, v40
v_exp_f32 v41, v41
v_exp_f32 v42, v42
v_exp_f32 v43, v43
v_cvt_pk_bf16_f32 v50, v40, v41
v_cvt_pk_bf16_f32 v51, v42, v43
v_mfma_f32_32x32x16_bf16 v[28:43], v[52:55], a[48:51], 0
ds_write_b128 v10, a[40:43] offset:2048
ds_write_b128 v10, a[44:47] offset:3072
buffer_load_dwordx4 a[24:27], v2, s[20:23], s82 offen offset:2048
v_exp_f32 v12, v12
v_exp_f32 v13, v13
v_exp_f32 v14, v14
v_exp_f32 v15, v15
v_cvt_pk_bf16_f32 v44, v12, v13
v_cvt_pk_bf16_f32 v45, v14, v15
v_mfma_f32_32x32x16_bf16 v[100:115], v[80:83], v[48:51], v[100:115]
buffer_load_dwordx4 a[28:31], v253, s[20:23], s82 offen offset:1024
v_exp_f32 v16, v16
v_exp_f32 v17, v17
v_exp_f32 v18, v18
v_exp_f32 v19, v19
v_cvt_pk_bf16_f32 v46, v16, v17
v_cvt_pk_bf16_f32 v47, v18, v19
v_mfma_f32_32x32x16_bf16 v[28:43], v[56:59], a[52:55], v[28:43]
s_waitcnt lgkmcnt(0)
s_barrier
buffer_load_dwordx4 a[32:35], v2, s[20:23], s83 offen offset:2048
ds_read_b128 v[80:83], v11 offset:3072
ds_read_b128 v[68:71], v11 offset:0
ds_read_b128 v[72:75], v11 offset:1024
ds_read_b128 v[76:79], v11 offset:2048
v_exp_f32 v20, v20
v_exp_f32 v21, v21
v_exp_f32 v22, v22
v_exp_f32 v23, v23
v_cvt_pk_bf16_f32 v48, v20, v21
v_cvt_pk_bf16_f32 v49, v22, v23
v_mfma_f32_32x32x16_bf16 v[100:115], v[92:95], v[44:47], v[100:115]
buffer_load_dwordx4 a[36:39], v253, s[20:23], s83 offen offset:1024
ds_read_b128 v[56:59], v11 offset:7168
ds_read_b128 v[84:87], v11 offset:4096
ds_read_b128 v[88:91], v11 offset:5120
ds_read_b128 v[52:55], v11 offset:6144
v_exp_f32 v24, v24
v_exp_f32 v25, v25
v_exp_f32 v26, v26
v_exp_f32 v27, v27
v_cvt_pk_bf16_f32 v50, v24, v25
v_cvt_pk_bf16_f32 v51, v26, v27
v_exp_f32 v28, v28
v_exp_f32 v29, v29
v_exp_f32 v30, v30
v_exp_f32 v31, v31
s_branch L_pf_s6
.p2align 12
L_pf_p6:
L_pf_e0_4:
s_sub_u32 s71, s71, 1
s_cbranch_scc1 L_pf_ret
s_branch L_pf_p8
L_pf_s6:
v_cvt_pk_bf16_f32 v44, v28, v29
v_cvt_pk_bf16_f32 v45, v30, v31
v_mfma_f32_32x32x16_bf16 v[100:115], v[96:99], v[48:51], v[100:115]
buffer_load_dwordx4 a[40:43], v2, s[20:23], s40 offen offset:2048
ds_read_b128 v[24:27], v11 offset:11264
ds_read_b128 v[12:15], v11 offset:8192
ds_read_b128 v[16:19], v11 offset:9216
ds_read_b128 v[20:23], v11 offset:10240
v_exp_f32 v32, v32
v_exp_f32 v33, v33
v_exp_f32 v34, v34
v_exp_f32 v35, v35
v_cvt_pk_bf16_f32 v46, v32, v33
v_cvt_pk_bf16_f32 v47, v34, v35
v_exp_f32 v36, v36
v_exp_f32 v37, v37
v_exp_f32 v38, v38
v_exp_f32 v39, v39
v_cvt_pk_bf16_f32 v48, v36, v37
v_cvt_pk_bf16_f32 v49, v38, v39
v_mfma_f32_32x32x16_bf16 v[100:115], v[60:63], v[44:47], v[100:115]
buffer_load_dwordx4 a[44:47], v253, s[20:23], s40 offen offset:1024
ds_read2st64_b64 v[96:99], v255 offset0:8 offset1:9
v_exp_f32 v40, v40
v_exp_f32 v41, v41
v_exp_f32 v42, v42
v_exp_f32 v43, v43
v_cvt_pk_bf16_f32 v50, v40, v41
v_cvt_pk_bf16_f32 v51, v42, v43
s_nop 1
v_mfma_f32_32x32x16_bf16 v[100:115], v[64:67], v[48:51], v[100:115]
s_waitcnt lgkmcnt(1)
buffer_load_dwordx4 a[48:51], v2, s[20:23], s51 offen offset:2048
v_add_f32 v24, v24, v80
v_add_f32 v25, v25, v81
v_add_f32 v12, v12, v68
v_add_f32 v13, v13, v69
v_add_f32 v14, v14, v70
v_add_f32 v15, v15, v71
v_add_f32 v16, v16, v72
v_add_f32 v17, v17, v73
v_pk_add_f32 v[24:25], v[24:25], v[56:57]
v_pk_add_f32 v[12:13], v[12:13], v[84:85]
v_pk_add_f32 v[14:15], v[14:15], v[86:87]
v_pk_add_f32 v[16:17], v[16:17], v[88:89]
v_pk_add_f32 v[112:113], v[112:113], v[24:25]
v_mov_b32 v8, v112
v_mov_b32 v9, v112
v_pk_add_f32 v[18:19], v[18:19], v[74:75]
v_pk_add_f32 v[20:21], v[20:21], v[76:77]
v_permlane32_swap_b32 v8, v9
v_pk_add_f32 v[22:23], v[22:23], v[78:79]
v_pk_add_f32 v[26:27], v[26:27], v[82:83]
v_rcp_f32 v10, v9
v_pk_add_f32 v[18:19], v[18:19], v[90:91]
v_pk_add_f32 v[20:21], v[20:21], v[52:53]
v_pk_add_f32 v[22:23], v[22:23], v[54:55]
v_pk_add_f32 v[26:27], v[26:27], v[58:59]
v_pk_add_f32 v[100:101], v[100:101], v[12:13]
v_pk_add_f32 v[102:103], v[102:103], v[14:15]
v_pk_add_f32 v[104:105], v[104:105], v[16:17]
v_pk_add_f32 v[106:107], v[106:107], v[18:19]
v_pk_add_f32 v[108:109], v[108:109], v[20:21]
v_pk_add_f32 v[110:111], v[110:111], v[22:23]
v_pk_add_f32 v[114:115], v[114:115], v[26:27]
v_pk_mul_f32 v[100:101], v[100:101], v[10:11] op_sel_hi:[1,0]
v_pk_mul_f32 v[102:103], v[102:103], v[10:11] op_sel_hi:[1,0]
v_cvt_pk_bf16_f32 v44, v100, v101
v_cvt_pk_bf16_f32 v45, v102, v103
s_waitcnt lgkmcnt(0)
ds_write2_b32 v96, v44, v45 offset0:0 offset1:224
v_max_f32 v8, 0x21800000, v9
v_min_f32 v8, 0x5d800000, v8
v_sub_f32 v8, v8, v9
v_lshl_add_u32 v11, v1, 2, s57
ds_write_b32 v11, v8
v_pk_mul_f32 v[104:105], v[104:105], v[10:11] op_sel_hi:[1,0]
v_pk_mul_f32 v[106:107], v[106:107], v[10:11] op_sel_hi:[1,0]
v_cvt_pk_bf16_f32 v46, v104, v105
v_cvt_pk_bf16_f32 v47, v106, v107
ds_write2_b32 v97, v46, v47 offset0:0 offset1:224
v_pk_mul_f32 v[108:109], v[108:109], v[10:11] op_sel_hi:[1,0]
v_pk_mul_f32 v[110:111], v[110:111], v[10:11] op_sel_hi:[1,0]
v_cvt_pk_bf16_f32 v48, v108, v109
v_cvt_pk_bf16_f32 v49, v110, v111
ds_write2_b32 v98, v48, v49 offset0:0 offset1:224
v_pk_mul_f32 v[112:113], v[112:113], v[10:11] op_sel_hi:[1,0]
v_pk_mul_f32 v[114:115], v[114:115], v[10:11] op_sel_hi:[1,0]
v_cvt_pk_bf16_f32 v50, v112, v113
v_cvt_pk_bf16_f32 v51, v114, v115
s_mov_b32 exec_hi, 0
ds_write2_b32 v99, v50, v51 offset0:0 offset1:224
s_mov_b32 exec_hi, -1
ds_read_u16_d16_hi v68, v3 offset:0
ds_read_u16_d16_hi v69, v3 offset:224
v_mov_b64 v[70:71], 0
ds_read_u16_d16_hi v72, v3 offset:32
ds_read_u16_d16_hi v73, v3 offset:256
v_mov_b64 v[74:75], 0
ds_read_u16_d16_hi v76, v3 offset:64
ds_read_u16_d16_hi v77, v3 offset:288
v_mov_b64 v[78:79], 0
ds_read_u16_d16_hi v80, v3 offset:96
ds_read_u16_d16_hi v81, v3 offset:320
v_mov_b64 v[82:83], 0
ds_read_u16_d16_hi v84, v3 offset:128
ds_read_u16_d16_hi v85, v3 offset:352
v_mov_b64 v[86:87], 0
ds_read_u16_d16_hi v88, v3 offset:160
ds_read_u16_d16_hi v89, v3 offset:384
v_mov_b64 v[90:91], 0
ds_read_u16_d16_hi v92, v3 offset:192
ds_read_u16_d16_hi v93, v3 offset:416
v_mov_b64 v[94:95], 0
s_waitcnt lgkmcnt(14)
s_barrier
ds_read_b128 v[12:15], v4
ds_read_b128 v[16:19], v4 offset:64
ds_read_b128 v[20:23], v4 offset:128
ds_read_b128 v[24:27], v4 offset:192
ds_read_b128 v[28:31], v4 offset:256
ds_read_b128 v[32:35], v4 offset:320
ds_read_b128 v[36:39], v4 offset:384
ds_read_b128 v[60:63], v0 offset:56384
ds_read_u16_d16_hi v52, v7 offset:2048
ds_read_u16_d16_hi v53, v7 offset:2080
ds_read_u16_d16_hi v54, v7 offset:2112
ds_read_u16_d16_hi v55, v7 offset:2144
ds_read_u16_d16_hi v56, v7 offset:2176
ds_read_u16_d16_hi v57, v7 offset:2208
ds_read_u16_d16_hi v58, v7 offset:2240
s_waitcnt lgkmcnt(14)
v_smfmac_f32_16x16x64_bf16 v[68:71], v[12:15], v[116:123], v254
buffer_load_dwordx4 a[52:55], v253, s[20:23], s51 offen offset:1024
v_smfmac_f32_16x16x64_bf16 v[72:75], v[12:15], v[172:179], v254
s_waitcnt lgkmcnt(13)
v_smfmac_f32_16x16x64_bf16 v[68:71], v[16:19], v[124:131], v254
v_smfmac_f32_16x16x64_bf16 v[72:75], v[16:19], v[180:187], v254
s_waitcnt lgkmcnt(12)
v_smfmac_f32_16x16x64_bf16 v[68:71], v[20:23], v[132:139], v254
s_add_u32 m0, s75, 0
v_smfmac_f32_16x16x64_bf16 v[72:75], v[20:23], v[188:195], v254
s_waitcnt lgkmcnt(11)
buffer_load_dwordx4 v5, s[68:71], s72 offen offset:0 lds
v_smfmac_f32_16x16x64_bf16 v[68:71], v[24:27], v[140:147], v254
v_smfmac_f32_16x16x64_bf16 v[72:75], v[24:27], v[196:203], v254
s_waitcnt lgkmcnt(10)
v_smfmac_f32_16x16x64_bf16 v[68:71], v[28:31], v[148:155], v254
v_smfmac_f32_16x16x64_bf16 v[72:75], v[28:31], v[204:211], v254
s_waitcnt lgkmcnt(9)
s_waitcnt lgkmcnt(7)
v_or3_b32 v60, v60, v61, v62
v_smfmac_f32_16x16x64_bf16 v[68:71], v[32:35], v[156:163], v254
s_waitcnt vmcnt(31)
v_or_b32 v60, v60, v63
v_smfmac_f32_16x16x64_bf16 v[72:75], v[32:35], v[212:219], v254
s_waitcnt vmcnt(22)
buffer_load_dwordx4 v5, s[68:71], s3 offen offset:1024 lds
v_cmp_ne_u32 vcc, 0, v60
s_branch L_pf_s7
L_pf_p7:
L_pf_e1_4:
s_sub_u32 s71, s71, 1
s_cbranch_scc1 L_pf_ret
s_branch L_pf_p9
L_pf_s7:
v_smfmac_f32_16x16x64_bf16 v[68:71], v[36:39], v[164:171], v254
s_waitcnt vmcnt(22)
s_cmp_lg_u64 vcc, 0
s_cbranch_scc1 L_k2_kernel_fallback
L_k2_kernel_fbno:
s_waitcnt lgkmcnt(5)
v_add_f32 v106, v52, v53
v_smfmac_f32_16x16x64_bf16 v[72:75], v[36:39], v[220:227], v254
s_waitcnt lgkmcnt(4)
v_add_f32 v106, v106, v54
v_smfmac_f32_16x16x64_bf16 v[76:79], v[12:15], v[228:235], v254
ds_read2st64_b64 v[212:215], v255 offset0:6 offset1:7
s_waitcnt lgkmcnt(4)
v_add_f32 v106, v106, v55
v_smfmac_f32_16x16x64_bf16 v[76:79], v[16:19], v[236:243], v254
s_waitcnt lgkmcnt(3)
v_add_f32 v106, v106, v56
v_smfmac_f32_16x16x64_bf16 v[76:79], v[20:23], v[244:251], v254
s_waitcnt lgkmcnt(2)
v_add_f32 v106, v106, v57
v_smfmac_f32_16x16x64_bf16 v[76:79], v[24:27], a[80:87], v254
buffer_load_dwordx4 v5, s[68:71], s8 offen offset:2048 lds
s_waitcnt lgkmcnt(1)
v_add_f32 v106, v106, v58
v_smfmac_f32_16x16x64_bf16 v[76:79], v[28:31], a[88:95], v254
v_smfmac_f32_16x16x64_bf16 v[76:79], v[32:35], a[96:103], v254
v_add_f32_dpp v106, v106, v106 row_ror:8 row_mask:0xf bank_mask:0xf
v_smfmac_f32_16x16x64_bf16 v[76:79], v[36:39], a[104:111], v254
v_smfmac_f32_16x16x64_bf16 v[80:83], v[12:15], a[112:119], v254
v_add_f32_dpp v109, v106, v106 row_half_mirror row_mask:0xf bank_mask:0xa
v_smfmac_f32_16x16x64_bf16 v[80:83], v[16:19], a[120:127], v254
v_add_f32 v68, v68, v70
v_smfmac_f32_16x16x64_bf16 v[80:83], v[20:23], a[128:135], v254
buffer_load_dwordx4 v5, s[68:71], s9 offen offset:3072 lds
v_add_f32 v69, v69, v71
v_smfmac_f32_16x16x64_bf16 v[80:83], v[24:27], a[136:143], v254
v_mul_f32 v102, v68, v68
v_smfmac_f32_16x16x64_bf16 v[80:83], v[28:31], a[144:151], v254
v_mul_f32 v103, v69, v69
v_smfmac_f32_16x16x64_bf16 v[80:83], v[32:35], a[152:159], v254
v_mul_f32 v104, v68, v52
v_smfmac_f32_16x16x64_bf16 v[80:83], v[36:39], a[160:167], v254
v_mul_f32 v105, v69, v52
v_smfmac_f32_16x16x64_bf16 v[84:87], v[12:15], a[168:175], v254
s_add_u32 m0, s75, 4096
v_add_f32 v72, v72, v74
v_smfmac_f32_16x16x64_bf16 v[84:87], v[16:19], a[176:183], v254
buffer_load_dwordx4 v5, s[68:71], s60 offen offset:0 lds
v_add_f32 v73, v73, v75
v_smfmac_f32_16x16x64_bf16 v[84:87], v[20:23], a[184:191], v254
v_fmac_f32 v102, v72, v72
v_smfmac_f32_16x16x64_bf16 v[84:87], v[24:27], a[192:199], v254
v_fmac_f32 v103, v73, v73
v_smfmac_f32_16x16x64_bf16 v[84:87], v[28:31], a[200:207], v254
v_fmac_f32 v104, v72, v53
v_smfmac_f32_16x16x64_bf16 v[84:87], v[32:35], a[208:215], v254
v_fmac_f32 v105, v73, v53
v_smfmac_f32_16x16x64_bf16 v[84:87], v[36:39], a[216:223], v254
v_add_f32 v100, v72, v68
v_smfmac_f32_16x16x64_bf16 v[88:91], v[12:15], a[224:231], v254
buffer_load_dwordx4 v5, s[68:71], s61 offen offset:1024 lds
v_add_f32 v101, v73, v69
v_smfmac_f32_16x16x64_bf16 v[88:91], v[16:19], a[232:239], v254
s_waitcnt vmcnt(24)
v_add_f32 v76, v76, v78
v_smfmac_f32_16x16x64_bf16 v[88:91], v[20:23], a[56:63], v254
s_waitcnt vmcnt(22)
v_add_f32 v77, v77, v79
v_smfmac_f32_16x16x64_bf16 v[88:91], v[24:27], a[64:71], v254
s_waitcnt vmcnt(20)
v_fmac_f32 v102, v76, v76
v_smfmac_f32_16x16x64_bf16 v[88:91], v[28:31], a[72:79], v254
s_waitcnt vmcnt(18)
v_fmac_f32 v103, v77, v77
v_smfmac_f32_16x16x64_bf16 v[88:91], v[32:35], a[0:7], v254
s_waitcnt vmcnt(16)
v_fmac_f32 v104, v76, v54
v_smfmac_f32_16x16x64_bf16 v[88:91], v[36:39], a[8:15], v254
buffer_load_dwordx4 v5, s[68:71], s58 offen offset:2048 lds
v_fmac_f32 v105, v77, v54
v_smfmac_f32_16x16x64_bf16 v[92:95], v[12:15], a[240:247], v254
v_add_f32 v100, v76, v100
v_smfmac_f32_16x16x64_bf16 v[92:95], v[16:19], a[248:255], v254
s_waitcnt vmcnt(15)
v_add_f32 v101, v77, v101
v_smfmac_f32_16x16x64_bf16 v[92:95], v[20:23], a[16:23], v254
s_waitcnt vmcnt(13)
v_add_f32 v80, v80, v82
v_smfmac_f32_16x16x64_bf16 v[92:95], v[24:27], a[24:31], v254
s_waitcnt vmcnt(11)
v_add_f32 v81, v81, v83
v_smfmac_f32_16x16x64_bf16 v[92:95], v[28:31], a[32:39], v254
s_waitcnt vmcnt(9)
v_fmac_f32 v102, v80, v80
v_smfmac_f32_16x16x64_bf16 v[92:95], v[32:35], a[40:47], v254
s_waitcnt vmcnt(7)
v_fmac_f32 v103, v81, v81
v_smfmac_f32_16x16x64_bf16 v[92:95], v[36:39], a[48:55], v254
v_fmac_f32 v104, v80, v55
v_fmac_f32 v105, v81, v55
v_pk_add_f32 v[100:101], v[80:81], v[100:101]
v_pk_add_f32 v[84:85], v[84:85], v[86:87]
v_pk_fma_f32 v[102:103], v[84:85], v[84:85], v[102:103]
v_pk_fma_f32 v[104:105], v[84:85], v[56:57], v[104:105] op_sel:[0,0,0] op_sel_hi:[1,0,1]
v_pk_add_f32 v[100:101], v[84:85], v[100:101]
v_pk_add_f32 v[88:89], v[88:89], v[90:91]
v_pk_fma_f32 v[102:103], v[88:89], v[88:89], v[102:103]
v_pk_fma_f32 v[104:105], v[88:89], v[56:57], v[104:105] op_sel:[0,1,0] op_sel_hi:[1,1,1]
v_pk_add_f32 v[100:101], v[88:89], v[100:101]
v_pk_add_f32 v[92:93], v[92:93], v[94:95]
v_pk_fma_f32 v[102:103], v[92:93], v[92:93], v[102:103]
v_pk_fma_f32 v[104:105], v[92:93], v[58:59], v[104:105] op_sel:[0,0,0] op_sel_hi:[1,0,1]
v_pk_add_f32 v[100:101], v[92:93], v[100:101]
v_add_f32_dpp v102, v102, v102 row_ror:8 row_mask:0xf bank_mask:0x3
v_add_f32_dpp v104, v104, v104 row_ror:8 row_mask:0xf bank_mask:0x3
v_add_f32_dpp v100, v100, v100 row_ror:8 row_mask:0xf bank_mask:0x3
v_add_f32_dpp v102, v103, v103 row_ror:8 row_mask:0xf bank_mask:0xc
v_add_f32_dpp v104, v105, v105 row_ror:8 row_mask:0xf bank_mask:0xc
v_add_f32_dpp v100, v101, v101 row_ror:8 row_mask:0xf bank_mask:0xc
v_add_f32_dpp v109, v102, v102 row_half_mirror row_mask:0xf bank_mask:0x5
v_add_f32_dpp v108, v104, v104 row_half_mirror row_mask:0xf bank_mask:0xa
v_lshlrev_b32 v219, 11, v1
v_mov_b32 v218, 0
v_add_f32_dpp v108, v100, v100 row_half_mirror row_mask:0xf bank_mask:0x5
v_add_f32_dpp v109, v109, v109 quad_perm:[1,0,3,2] row_mask:0xf bank_mask:0xf
v_add_u32 v216, s44, v0
v_add_f32_dpp v108, v108, v108 quad_perm:[1,0,3,2] row_mask:0xf bank_mask:0xf
v_add_f32_dpp v109, v109, v109 quad_perm:[2,3,0,1] row_mask:0xf bank_mask:0xf
v_add_u32 v217, s74, v0
v_add_f32_dpp v108, v108, v108 quad_perm:[2,3,0,1] row_mask:0xf bank_mask:0xf
s_waitcnt lgkmcnt(0)
ds_write_b64 v213, v[108:109]
s_waitcnt lgkmcnt(0)
s_barrier
ds_read_b128 v[180:183], v212 offset:0
ds_read_b128 v[184:187], v212 offset:128
ds_read_b128 v[188:191], v212 offset:256
ds_read_b128 v[192:195], v212 offset:384
s_waitcnt lgkmcnt(2)
v_pk_add_f32 v[180:181], v[180:181], v[184:185]
s_waitcnt lgkmcnt(0)
v_pk_add_f32 v[188:189], v[188:189], v[192:193]
v_pk_add_f32 v[182:183], v[182:183], v[186:187]
v_pk_add_f32 v[190:191], v[190:191], v[194:195]
v_pk_add_f32 v[180:181], v[180:181], v[188:189]
v_pk_add_f32 v[182:183], v[182:183], v[190:191]
v_mul_f32 v180, 0x3b124925, v180
v_mul_f32 v181, 0x3b124925, v181
v_fma_f32 v181, -v180, v180, v181
v_max_f32 v181, 0, v181
v_cvt_pk_bf16_f32 v184, 0, v180
v_cvt_pk_bf16_f32 v185, 0, v181
v_add_f32 v185, 0x3727c5ac, v185
v_cvt_pk_bf16_f32 v185, 0, v185
v_sqrt_f32 v185, v185
s_nop 0
v_cvt_pk_bf16_f32 v185, 0, v185
v_rcp_f32 v187, v185
s_nop 0
v_mul_f32_e64 v186, -v184, v187
v_mul_f32 v183, v183, v186
s_branch L_pf_s8
L_pf_p8:
L_pf_e0_5:
s_sub_u32 s71, s71, 1
s_cbranch_scc1 L_pf_ret
s_branch L_pf_p10
L_pf_s8:
v_fma_f32 v188, -v182, v187, -v183
v_ashrrev_i32 v183, 31, v188
v_or_b32 v183, 0x80000000, v183
v_xor_b32 v188, v188, v183
v_and_b32 v188, 0xffffe000, v188
v_or_b32 v188, v188, v214
v_mov_b32_dpp v100, v187 row_newbcast:0 row_mask:0xf bank_mask:0xf
v_mov_b32_dpp v102, v186 row_newbcast:0 row_mask:0xf bank_mask:0xf
v_mov_b32_dpp v192, v188 quad_perm:[1,0,3,2] row_mask:0xf bank_mask:0xf
v_max_u32 v191, v188, v192
v_min_u32 v190, v188, v192
v_mov_b32_dpp v101, v187 row_newbcast:1 row_mask:0xf bank_mask:0xf
v_mov_b32_dpp v103, v186 row_newbcast:1 row_mask:0xf bank_mask:0xf
v_mov_b32_dpp v192, v190 quad_perm:[2,3,0,1] row_mask:0xf bank_mask:0xf
v_min_u32_dpp v193, v191, v191 quad_perm:[2,3,0,1] row_mask:0xf bank_mask:0xf
v_med3_u32 v191, v190, v192, v193
v_min_u32 v190, v190, v192
v_pk_fma_f32 v[196:197], v[68:69], v[100:101], v[102:103]
v_pk_fma_f32 v[198:199], v[72:73], v[100:101], v[102:103]
v_mov_b32_dpp v192, v190 row_half_mirror row_mask:0xf bank_mask:0xf
v_min_u32_dpp v193, v191, v191 row_half_mirror row_mask:0xf bank_mask:0xf
v_med3_u32 v191, v190, v192, v193
v_min_u32 v190, v190, v192
v_xor_b32 v190, 8, v190
s_mov_b64 exec, 0xffff
buffer_store_dwordx2 v[190:191], v219, s[12:15], s86 offen sc1
s_mov_b64 exec, -1
v_cndmask_b32_e64 v192, v190, v191, s[100:101]
v_and_b32 v192, 7, v192
v_mad_u32_u24 v217, v192, s43, v217
v_add_u32 v227, s87, v217
v_pk_fma_f32 v[200:201], v[76:77], v[100:101], v[102:103]
v_pk_fma_f32 v[202:203], v[80:81], v[100:101], v[102:103]
v_pk_fma_f32 v[204:205], v[84:85], v[100:101], v[102:103]
v_pk_fma_f32 v[206:207], v[88:89], v[100:101], v[102:103]
v_pk_fma_f32 v[208:209], v[92:93], v[100:101], v[102:103]
v_cvt_pk_bf16_f32 v168, v196, v197
v_pk_add_f32 v[68:69], v[68:69], v[196:197]
ds_write_b16 v215, v168 offset:0
v_cvt_pk_bf16_f32 v220, v68, v69
ds_write_b16_d16_hi v215, v168 offset:1808
ds_write_b16 v215, v220 offset:896
ds_write_b16_d16_hi v215, v220 offset:2704
v_cvt_pk_bf16_f32 v169, v198, v199
v_pk_add_f32 v[72:73], v[72:73], v[198:199]
ds_write_b16 v215, v169 offset:32
v_cvt_pk_bf16_f32 v221, v72, v73
ds_write_b16_d16_hi v215, v169 offset:1840
ds_write_b16 v215, v221 offset:928
ds_write_b16_d16_hi v215, v221 offset:2736
v_cvt_pk_bf16_f32 v170, v200, v201
v_pk_add_f32 v[76:77], v[76:77], v[200:201]
ds_write_b16 v215, v170 offset:64
v_cvt_pk_bf16_f32 v222, v76, v77
ds_write_b16_d16_hi v215, v170 offset:1872
ds_write_b16 v215, v222 offset:960
ds_write_b16_d16_hi v215, v222 offset:2768
v_cvt_pk_bf16_f32 v171, v202, v203
v_pk_add_f32 v[80:81], v[80:81], v[202:203]
ds_write_b16 v215, v171 offset:96
v_cvt_pk_bf16_f32 v223, v80, v81
ds_write_b16_d16_hi v215, v171 offset:1904
ds_write_b16 v215, v223 offset:992
ds_write_b16_d16_hi v215, v223 offset:2800
v_cvt_pk_bf16_f32 v172, v204, v205
v_pk_add_f32 v[84:85], v[84:85], v[204:205]
ds_write_b16 v215, v172 offset:128
v_cvt_pk_bf16_f32 v224, v84, v85
ds_write_b16_d16_hi v215, v172 offset:1936
ds_write_b16 v215, v224 offset:1024
ds_write_b16_d16_hi v215, v224 offset:2832
v_cvt_pk_bf16_f32 v173, v206, v207
v_pk_add_f32 v[88:89], v[88:89], v[206:207]
ds_write_b16 v215, v173 offset:160
v_cvt_pk_bf16_f32 v225, v88, v89
ds_write_b16_d16_hi v215, v173 offset:1968
ds_write_b16 v215, v225 offset:1056
ds_write_b16_d16_hi v215, v225 offset:2864
v_cvt_pk_bf16_f32 v174, v208, v209
v_pk_add_f32 v[92:93], v[92:93], v[208:209]
ds_write_b16 v215, v174 offset:192
v_cvt_pk_bf16_f32 v226, v92, v93
ds_write_b16_d16_hi v215, v174 offset:2000
ds_write_b16 v215, v226 offset:1088
ds_write_b16_d16_hi v215, v226 offset:2896
s_waitcnt vmcnt(1)
s_cmp_eq_u32 s36, 0
s_cbranch_scc1 L_k2_kernel_w0
s_mov_b32 exec_hi, 0x00ffffff
s_waitcnt lgkmcnt(0)
s_barrier
ds_read_b128 v[156:159], v217
ds_read_b128 v[228:231], v227
ds_read_b128 v[160:163], v216
ds_read_b128 v[164:167], v216 offset:1808
s_waitcnt lgkmcnt(3)
buffer_store_dwordx4 v[156:159], v0, s[4:7], s59 offen sc1
s_waitcnt lgkmcnt(2)
buffer_store_dwordx4 v[228:231], v0, s[4:7], s59 offen offset:896 sc1
s_waitcnt lgkmcnt(1)
buffer_store_dwordx4 v[160:163], v0, s[28:31], s52 offen sc0 sc1
s_waitcnt lgkmcnt(0)
buffer_store_dwordx4 v[164:167], v0, s[28:31], s52 offen offset:896 sc0 sc1
s_mov_b32 exec_hi, -1
s_branch L_k2_kernel_other
L_pf_p9:
L_pf_e1_5:
s_sub_u32 s71, s71, 1
s_cbranch_scc1 L_pf_ret
s_branch L_pf_p11
L_k2_kernel_w0:
s_waitcnt lgkmcnt(0)
s_barrier
s_cmp_lg_u32 s76, 1
s_cbranch_scc1 L_k2_kernel_other
v_and_b32 v28, 0x17, v1
v_lshlrev_b32 v31, 3, v28
v_and_b32 v29, 0x20, v1
v_lshl_add_u32 v31, v29, 4, v31
v_and_b32 v30, 8, v1
v_lshl_add_u32 v31, v30, 5, v31
v_add_u32 v31, s75, v31
ds_read_b64_tr_b16 a[0:1], v31 offset:0
ds_read_b64_tr_b16 a[2:3], v31 offset:64
ds_read_b64_tr_b16 a[4:5], v31 offset:1024
ds_read_b64_tr_b16 a[6:7], v31 offset:1088
ds_read_b64_tr_b16 a[8:9], v31 offset:2048
ds_read_b64_tr_b16 a[10:11], v31 offset:2112
ds_read_b64_tr_b16 a[12:13], v31 offset:3072
ds_read_b64_tr_b16 a[14:15], v31 offset:3136
ds_read_b64_tr_b16 a[16:17], v31 offset:4096
ds_read_b64_tr_b16 a[18:19], v31 offset:4160
ds_read_b64_tr_b16 a[20:21], v31 offset:5120
ds_read_b64_tr_b16 a[22:23], v31 offset:5184
ds_read_b64_tr_b16 a[24:25], v31 offset:6144
ds_read_b64_tr_b16 a[26:27], v31 offset:6208
ds_read_b64_tr_b16 a[56:57], v31 offset:14336
ds_read_b64_tr_b16 a[58:59], v31 offset:14400
ds_read_b64_tr_b16 a[60:61], v31 offset:15360
ds_read_b64_tr_b16 a[62:63], v31 offset:15424
ds_read_b64_tr_b16 a[64:65], v31 offset:16384
ds_read_b64_tr_b16 a[66:67], v31 offset:16448
ds_read_b64_tr_b16 a[68:69], v31 offset:17408
ds_read_b64_tr_b16 a[70:71], v31 offset:17472
ds_read_b64_tr_b16 a[72:73], v31 offset:18432
ds_read_b64_tr_b16 a[74:75], v31 offset:18496
ds_read_b64_tr_b16 a[76:77], v31 offset:19456
ds_read_b64_tr_b16 a[78:79], v31 offset:19520
ds_read_b64_tr_b16 a[80:81], v31 offset:20480
ds_read_b64_tr_b16 a[82:83], v31 offset:20544
ds_read_b64_tr_b16 a[28:29], v31 offset:28672
ds_read_b64_tr_b16 a[30:31], v31 offset:28736
ds_read_b64_tr_b16 a[32:33], v31 offset:29696
ds_read_b64_tr_b16 a[34:35], v31 offset:29760
ds_read_b64_tr_b16 a[36:37], v31 offset:30720
ds_read_b64_tr_b16 a[38:39], v31 offset:30784
ds_read_b64_tr_b16 a[40:41], v31 offset:31744
ds_read_b64_tr_b16 a[42:43], v31 offset:31808
ds_read_b64_tr_b16 a[44:45], v31 offset:32768
ds_read_b64_tr_b16 a[46:47], v31 offset:32832
ds_read_b64_tr_b16 a[48:49], v31 offset:33792
ds_read_b64_tr_b16 a[50:51], v31 offset:33856
ds_read_b64_tr_b16 a[52:53], v31 offset:34816
ds_read_b64_tr_b16 a[54:55], v31 offset:34880
ds_read_b64_tr_b16 a[84:85], v31 offset:43008
ds_read_b64_tr_b16 a[86:87], v31 offset:43072
ds_read_b64_tr_b16 a[88:89], v31 offset:44032
ds_read_b64_tr_b16 a[90:91], v31 offset:44096
ds_read_b64_tr_b16 a[92:93], v31 offset:45056
ds_read_b64_tr_b16 a[94:95], v31 offset:45120
ds_read_b64_tr_b16 a[96:97], v31 offset:46080
ds_read_b64_tr_b16 a[98:99], v31 offset:46144
ds_read_b64_tr_b16 a[100:101], v31 offset:47104
ds_read_b64_tr_b16 a[102:103], v31 offset:47168
ds_read_b64_tr_b16 a[104:105], v31 offset:48128
ds_read_b64_tr_b16 a[106:107], v31 offset:48192
ds_read_b64_tr_b16 a[108:109], v31 offset:49152
ds_read_b64_tr_b16 a[110:111], v31 offset:49216
v_bfe_u32 v29, v1, 2, 1
v_and_b32 v33, 16, v1
v_lshl_add_u32 v33, v29, 3, v33
v_and_b32 v29, 8, v1
v_lshl_add_u32 v33, v29, 2, v33
v_lshrrev_b32 v29, 5, v1
v_and_b32 v30, 3, v1
v_lshl_add_u32 v29, v29, 2, v30
v_mul_u32_u24 v29, 7168, v29
v_add_u32 v33, v33, v29
s_lshl_b32 s49, s77, 6
s_add_u32 s49, s49, 0x378000
s_sleep 5
buffer_load_dwordx4 v[12:15], v0, s[12:15], s85 offen sc1
buffer_load_dwordx4 v[16:19], v0, s[12:15], s85 offen offset:1024 sc1
v_and_b32 v30, 3, v1
v_and_b32 v28, 0x38, v1
v_lshlrev_b32 v28, 1, v28
v_lshl_add_u32 v32, v30, 7, v28
v_min_u32 v30, 2, v30
v_lshl_add_u32 v4, v30, 7, v28
v_sub_u32 v4, v4, v32
s_mov_b32 s80, 0xf0f0f0f0
s_mov_b32 s81, 0xf0f0f0f0
s_movk_i32 s82, 224
s_mov_b32 s83, 0x270000
v_bfe_i32 v35, v1, 3, 1
v_and_b32 v35, 0xaaaaaaaa, v35
v_or_b32 v35, 0x44444444, v35
s_waitcnt vmcnt(0) lgkmcnt(0)
L_k2_kernel_kca:
v_max3_u32 v28, v12, v14, v16
v_max_u32 v28, v28, v18
v_cmp_eq_u32 vcc, -1, v28
s_nop 0
s_cmp_lg_u64 vcc, 0
s_cbranch_scc1 L_k2_kernel_kra
v_min_u32 v29, v13, v15
v_med3_u32 v9, v12, v14, v29
v_min_u32 v8, v12, v14
v_min_u32 v29, v9, v17
v_med3_u32 v9, v8, v16, v29
v_min_u32 v8, v8, v16
v_min_u32 v29, v9, v19
v_med3_u32 v9, v8, v18, v29
v_min_u32 v8, v8, v18
s_nop 0
v_min_u32_dpp v29, v9, v9 quad_perm:[1,0,3,2] row_mask:0xf bank_mask:0xf
v_mov_b32_dpp v28, v8 quad_perm:[1,0,3,2] row_mask:0xf bank_mask:0xf
v_med3_u32 v9, v8, v28, v29
v_min_u32 v8, v8, v28
s_nop 0
v_min_u32_dpp v29, v9, v9 quad_perm:[2,3,0,1] row_mask:0xf bank_mask:0xf
v_mov_b32_dpp v28, v8 quad_perm:[2,3,0,1] row_mask:0xf bank_mask:0xf
v_med3_u32 v9, v8, v28, v29
v_min_u32 v8, v8, v28
s_nop 0
v_min_u32_dpp v29, v9, v9 row_half_mirror row_mask:0xf bank_mask:0xf
v_mov_b32_dpp v28, v8 row_half_mirror row_mask:0xf bank_mask:0xf
v_med3_u32 v9, v8, v28, v29
v_min_u32 v8, v8, v28
s_nop 0
v_min_u32_dpp v29, v9, v9 row_mirror row_mask:0xf bank_mask:0xf
v_mov_b32_dpp v28, v8 row_mirror row_mask:0xf bank_mask:0xf
v_med3_u32 v9, v8, v28, v29
v_min_u32 v8, v8, v28
v_mov_b32 v29, v9
v_mov_b32 v28, v8
s_nop 0
v_permlane16_swap_b32 v9, v29
v_permlane16_swap_b32 v8, v28
v_min_u32 v29, v9, v29
v_med3_u32 v9, v8, v28, v29
v_min_u32 v8, v8, v28
v_mov_b32 v29, v9
v_mov_b32 v28, v8
s_nop 0
v_permlane32_swap_b32 v9, v29
v_permlane32_swap_b32 v8, v28
v_min_u32 v29, v9, v29
v_med3_u32 v9, v8, v28, v29
v_min_u32 v8, v8, v28
v_cndmask_b32_e64 v28, v8, v9, s[80:81]
v_and_b32 v29, 0xff0, v28
v_and_b32 v28, 8, v28
v_lshl_add_u32 v32, v29, 8, v32
v_mad_u32_u24 v32, v28, s82, v32
s_mov_b32 s79, 2000
v_add_u32 v4, v4, v32
L_k2_kernel_rpa:
buffer_load_dwordx4 v[20:23], v32, s[12:15], s83 offen sc1
s_branch L_pf_s10
L_pf_p10:
L_pf_e0_6:
s_sub_u32 s71, s71, 1
s_cbranch_scc1 L_pf_ret
s_branch L_pf_p12
L_pf_s10:
buffer_load_dwordx4 v[24:27], v4, s[12:15], s83 offen offset:512 sc1
v_mov_b64 v[36:37], 0
v_mov_b64 v[38:39], 0
v_mov_b64 v[40:41], 0
v_mov_b64 v[42:43], 0
v_mov_b64 v[44:45], 0
v_mov_b64 v[46:47], 0
v_mov_b64 v[48:49], 0
v_mov_b64 v[50:51], 0
v_mov_b64 v[52:53], 0
v_mov_b64 v[54:55], 0
v_mov_b64 v[56:57], 0
v_mov_b64 v[58:59], 0
v_mov_b64 v[60:61], 0
v_mov_b64 v[62:63], 0
v_mov_b64 v[64:65], 0
v_mov_b64 v[66:67], 0
s_waitcnt vmcnt(1)
v_smfmac_f32_16x16x64_bf16 v[36:39], v[20:23], a[0:7], v35
s_waitcnt vmcnt(0)
v_max3_u32 v28, v20, v22, v24
v_smfmac_f32_16x16x64_bf16 v[40:43], v[20:23], a[8:15], v35
v_max_u32 v28, v28, v26
v_cmp_eq_u32 vcc, -1, v28
v_smfmac_f32_16x16x64_bf16 v[44:47], v[20:23], a[16:23], v35
s_cmp_lg_u64 vcc, 0
s_cbranch_scc1 L_k2_kernel_rra
L_k2_kernel_roa:
v_smfmac_f32_16x16x64_bf16 v[48:51], v[20:23], a[24:31], v35
v_smfmac_f32_16x16x64_bf16 v[36:39], v[24:27], a[32:39], v35
v_smfmac_f32_16x16x64_bf16 v[40:43], v[24:27], a[40:47], v35
s_nop 0
s_nop 0
s_nop 0
v_smfmac_f32_16x16x64_bf16 v[44:47], v[24:27], a[48:55], v35
s_nop 0
s_branch L_pf_s11
.p2align 12
L_pf_p11:
L_pf_e1_6:
s_sub_u32 s71, s71, 1
s_cbranch_scc1 L_pf_ret
s_branch L_pf_p13
L_pf_s11:
s_nop 0
s_nop 0
v_smfmac_f32_16x16x64_bf16 v[52:55], v[20:23], a[56:63], v35
v_add_f32 v92, v51, v36
v_add_f32 v92, v92, v41
v_smfmac_f32_16x16x64_bf16 v[56:59], v[20:23], a[64:71], v35
s_nop 0
v_add_f32 v93, v92, v46
v_add_f32 v92, v92, v46
v_smfmac_f32_16x16x64_bf16 v[60:63], v[20:23], a[72:79], v35
s_nop 0
v_permlane32_swap_b32 v92, v93
v_add_f32 v92, v92, v93
v_smfmac_f32_16x16x64_bf16 v[64:67], v[20:23], a[80:87], v35
v_cvt_pk_bf16_f32 v92, 0, v92
v_mul_f32 v100, 0xbfb8aa3b, v92
v_smfmac_f32_16x16x64_bf16 v[52:55], v[24:27], a[88:95], v35
v_exp_f32 v100, v100
s_nop 0
v_add_f32 v100, 1.0, v100
v_smfmac_f32_16x16x64_bf16 v[56:59], v[24:27], a[96:103], v35
v_rcp_f32 v100, v100
s_nop 0
v_mul_f32 v92, v92, v100
v_smfmac_f32_16x16x64_bf16 v[60:63], v[24:27], a[104:111], v35
v_cvt_pk_bf16_f32 v92, 0, v92
s_nop 0
v_add_f32 v96, v67, v52
s_nop 0
v_add_f32 v96, v96, v57
s_nop 0
s_nop 0
s_nop 0
v_add_f32 v97, v96, v62
v_add_f32 v96, v96, v62
s_nop 0
s_nop 0
v_permlane32_swap_b32 v96, v97
v_add_f32 v96, v96, v97
v_cvt_pk_bf16_f32 v96, 0, v96
v_mul_f32 v92, v92, v96
s_nop 1
v_mov_b32_dpp v102, v92 quad_perm:[0,0,0,0] row_mask:0xf bank_mask:0xf
v_mov_b32_dpp v103, v92 quad_perm:[1,1,1,1] row_mask:0xf bank_mask:0xf
v_mov_b32_dpp v104, v92 quad_perm:[2,2,2,2] row_mask:0xf bank_mask:0xf
v_mov_b32_dpp v105, v92 quad_perm:[3,3,3,3] row_mask:0xf bank_mask:0xf
v_cvt_pk_bf16_f32 v100, v102, v103
v_cvt_pk_bf16_f32 v101, v104, v105
buffer_store_dwordx2 v[100:101], v33, s[12:15], s49 offen sc1
s_endpgm
L_k2_kernel_other:
s_cmp_eq_u32 s76, 2
s_cbranch_scc1 L_k2_kernel_b
s_waitcnt vmcnt(0)
s_mov_b64 exec, 1
buffer_store_dword v218, off, s[12:15], s84 offset:3584 sc1
s_mov_b64 exec, -1
L_k2_kernel_schk:
s_cmp_lg_u32 s36, 3
s_cbranch_scc1 L_k2_kernel_fin
s_mov_b32 s46, 0x386000
buffer_load_dword v28, off, s[12:15], s46 sc1
s_waitcnt vmcnt(0)
v_readfirstlane_b32 s46, v28
s_nop 0
s_cmp_lg_u32 s46, -1
s_cbranch_scc1 L_k2_kernel_gchk
L_k2_kernel_fin:
s_endpgm
L_k2_kernel_b:
s_add_u32 s72, s58, s73
s_add_u32 s72, s72, 2048
s_add_u32 m0, s75, 7168
s_nop 0
buffer_load_dwordx4 v5, s[68:71], s72 offen lds
s_add_u32 s72, s72, s73
s_add_u32 m0, s75, 8192
s_nop 0
buffer_load_dwordx4 v5, s[68:71], s72 offen lds
s_add_u32 s72, s72, s73
s_add_u32 m0, s75, 9216
s_nop 0
buffer_load_dwordx4 v5, s[68:71], s72 offen lds
s_add_u32 s72, s72, s73
s_add_u32 m0, s75, 10240
s_nop 0
buffer_load_dwordx4 v5, s[68:71], s72 offen lds
s_add_u32 s72, s72, s73
s_add_u32 m0, s75, 11264
s_nop 0
buffer_load_dwordx4 v5, s[68:71], s72 offen lds
s_add_u32 s72, s72, s73
s_add_u32 m0, s75, 12288
s_nop 0
buffer_load_dwordx4 v5, s[68:71], s72 offen lds
s_add_u32 s72, s72, s73
s_add_u32 m0, s75, 13312
s_nop 0
buffer_load_dwordx4 v5, s[68:71], s72 offen lds
v_and_b32 v28, 0x17, v1
v_lshlrev_b32 v31, 3, v28
v_and_b32 v29, 0x20, v1
v_lshl_add_u32 v31, v29, 4, v31
v_and_b32 v30, 8, v1
v_lshl_add_u32 v31, v30, 5, v31
v_add_u32 v31, s75, v31
v_mov_b32 v34, 57408
s_mul_i32 s48, s36, 1792
s_and_b32 s49, s2, 7
s_mul_i32 s49, s49, 7168
s_add_u32 s49, s49, s48
s_add_u32 s49, s49, 0x378000
v_and_b32 v29, 0x3c, v1
v_lshlrev_b32 v29, 2, v29
v_and_b32 v30, 3, v1
v_lshl_add_u32 v32, v30, 8, v29
v_min_u32 v30, 2, v30
v_lshl_add_u32 v4, v30, 8, v29
s_lshl_b32 s46, s36, 8
s_add_u32 s46, s46, 17664
v_lshl_add_u32 v3, v1, 2, s46
v_and_b32 v33, 15, v1
s_lshl_b32 s46, s77, 5
v_lshl_add_u32 v33, v33, 1, s46
v_bfe_i32 v35, v1, 3, 1
v_and_b32 v35, 0xaaaaaaaa, v35
v_or_b32 v35, 0x44444444, v35
s_cmp_lg_u32 s36, 0
s_cbranch_scc1 L_k2_kernel_b1
s_sleep 6
buffer_load_dwordx4 v[12:15], v0, s[12:15], s85 offen sc1
buffer_load_dwordx4 v[16:19], v0, s[12:15], s85 offen offset:1024 sc1
s_waitcnt vmcnt(0)
L_k2_kernel_kcb:
v_max3_u32 v28, v12, v14, v16
v_max_u32 v28, v28, v18
v_cmp_eq_u32 vcc, -1, v28
s_nop 0
s_cmp_lg_u64 vcc, 0
s_cbranch_scc1 L_k2_kernel_krb
v_min_u32 v29, v13, v15
v_med3_u32 v9, v12, v14, v29
v_min_u32 v8, v12, v14
v_min_u32 v29, v9, v17
v_med3_u32 v9, v8, v16, v29
v_min_u32 v8, v8, v16
v_min_u32 v29, v9, v19
v_med3_u32 v9, v8, v18, v29
v_min_u32 v8, v8, v18
s_nop 0
v_min_u32_dpp v29, v9, v9 quad_perm:[1,0,3,2] row_mask:0xf bank_mask:0xf
v_mov_b32_dpp v28, v8 quad_perm:[1,0,3,2] row_mask:0xf bank_mask:0xf
v_med3_u32 v9, v8, v28, v29
v_min_u32 v8, v8, v28
s_nop 0
v_min_u32_dpp v29, v9, v9 quad_perm:[2,3,0,1] row_mask:0xf bank_mask:0xf
v_mov_b32_dpp v28, v8 quad_perm:[2,3,0,1] row_mask:0xf bank_mask:0xf
v_med3_u32 v9, v8, v28, v29
v_min_u32 v8, v8, v28
s_nop 0
v_min_u32_dpp v29, v9, v9 row_half_mirror row_mask:0xf bank_mask:0xf
v_mov_b32_dpp v28, v8 row_half_mirror row_mask:0xf bank_mask:0xf
v_med3_u32 v9, v8, v28, v29
v_min_u32 v8, v8, v28
s_nop 0
v_min_u32_dpp v29, v9, v9 row_mirror row_mask:0xf bank_mask:0xf
v_mov_b32_dpp v28, v8 row_mirror row_mask:0xf bank_mask:0xf
v_med3_u32 v9, v8, v28, v29
v_min_u32 v8, v8, v28
v_mov_b32 v29, v9
v_mov_b32 v28, v8
s_nop 0
v_permlane16_swap_b32 v9, v29
v_permlane16_swap_b32 v8, v28
v_min_u32 v29, v9, v29
v_med3_u32 v9, v8, v28, v29
v_min_u32 v8, v8, v28
v_mov_b32 v29, v9
v_mov_b32 v28, v8
s_nop 0
v_permlane32_swap_b32 v9, v29
v_permlane32_swap_b32 v8, v28
v_min_u32 v29, v9, v29
v_med3_u32 v9, v8, v28, v29
v_min_u32 v8, v8, v28
v_mov_b32 v10, 0
v_mov_b32 v11, 0
ds_write_b128 v34, v[8:11]
s_mov_b32 vcc_lo, 0xffff0000
s_mov_b32 vcc_hi, 0xffff0000
v_cndmask_b32 v106, v8, v9, vcc
v_and_b32 v28, 0xff0, v106
v_lshlrev_b32 v5, 8, v28
v_and_b32 v29, 8, v106
v_mul_u32_u24 v29, 224, v29
v_add3_u32 v7, v5, v29, v33
v_lshrrev_b32 v28, 1, v28
s_branch L_pf_s12
L_pf_p12:
L_pf_e0_7:
s_sub_u32 s71, s71, 1
s_cbranch_scc1 L_pf_ret
s_branch L_pf_p0
L_pf_s12:
v_and_b32 v29, 7, v106
v_add_u32 v28, v28, v29
v_mul_u32_u24 v28, 896, v28
v_add_u32 v33, v33, v28
v_and_b32 v106, 0xffffe000, v106
v_ashrrev_i32 v28, 31, v106
v_not_b32 v28, v28
v_or_b32 v28, 0x80000000, v28
v_xor_b32 v106, v106, v28
v_cvt_pk_bf16_f32 v106, 0, v106
v_mul_f32 v106, 0x3fb8aa3b, v106
v_exp_f32 v106, v106
s_nop 0
v_add_f32 v106, 1.0, v106
v_rcp_f32 v106, v106
s_nop 0
v_cvt_pk_bf16_f32 v106, 0, v106
s_waitcnt lgkmcnt(0)
s_nop 15
L_k2_kernel_b1:
s_waitcnt vmcnt(0)
s_mov_b64 exec, 1
buffer_store_dword v218, off, s[12:15], s84 offset:3584 sc1
s_mov_b64 exec, -1
ds_read_b64_tr_b16 a[0:1], v31 offset:0
ds_read_b64_tr_b16 a[2:3], v31 offset:64
ds_read_b64_tr_b16 a[4:5], v31 offset:1024
ds_read_b64_tr_b16 a[6:7], v31 offset:1088
ds_read_b64_tr_b16 a[8:9], v31 offset:2048
ds_read_b64_tr_b16 a[10:11], v31 offset:2112
ds_read_b64_tr_b16 a[12:13], v31 offset:3072
ds_read_b64_tr_b16 a[14:15], v31 offset:3136
ds_read_b64_tr_b16 a[16:17], v31 offset:4096
ds_read_b64_tr_b16 a[18:19], v31 offset:4160
ds_read_b64_tr_b16 a[20:21], v31 offset:5120
ds_read_b64_tr_b16 a[22:23], v31 offset:5184
ds_read_b64_tr_b16 a[24:25], v31 offset:6144
ds_read_b64_tr_b16 a[26:27], v31 offset:6208
ds_read_b64_tr_b16 a[28:29], v31 offset:7168
ds_read_b64_tr_b16 a[30:31], v31 offset:7232
ds_read_b64_tr_b16 a[32:33], v31 offset:8192
ds_read_b64_tr_b16 a[34:35], v31 offset:8256
ds_read_b64_tr_b16 a[36:37], v31 offset:9216
ds_read_b64_tr_b16 a[38:39], v31 offset:9280
ds_read_b64_tr_b16 a[40:41], v31 offset:10240
ds_read_b64_tr_b16 a[42:43], v31 offset:10304
ds_read_b64_tr_b16 a[44:45], v31 offset:11264
ds_read_b64_tr_b16 a[46:47], v31 offset:11328
ds_read_b64_tr_b16 a[48:49], v31 offset:12288
ds_read_b64_tr_b16 a[50:51], v31 offset:12352
ds_read_b64_tr_b16 a[52:53], v31 offset:13312
ds_read_b64_tr_b16 a[54:55], v31 offset:13376
s_waitcnt lgkmcnt(0)
s_barrier
ds_read_b32 v28, v34 offset:8
s_mov_b32 s79, 2000
s_waitcnt lgkmcnt(0)
v_readfirstlane_b32 s46, v28
s_nop 0
s_cmp_lg_u32 s46, 0
s_cbranch_scc1 L_k2_kernel_schk
s_waitcnt vmcnt(0)
s_sleep 15
s_cmp_eq_u32 s36, 0
s_mov_b32 s46, 0x10000000
s_cselect_b32 s46, 0x270000, s46
L_k2_kernel_ap:
buffer_load_dwordx4 v[20:23], v32, s[12:15], s49 offen sc1
buffer_load_dwordx4 v[24:27], v4, s[12:15], s49 offen offset:1024 sc1
buffer_load_ushort v104, v7, s[12:15], s46 offen offset:896 sc1
buffer_load_dwordx4 v[108:111], v5, s[12:15], s46 offen offset:3584 sc1
v_mov_b64 v[36:37], 0
v_mov_b64 v[38:39], 0
v_mov_b64 v[40:41], 0
v_mov_b64 v[42:43], 0
v_mov_b64 v[44:45], 0
v_mov_b64 v[46:47], 0
v_mov_b64 v[48:49], 0
v_mov_b64 v[50:51], 0
s_waitcnt vmcnt(3)
v_smfmac_f32_16x16x64_bf16 v[36:39], v[20:23], a[0:7], v35
s_waitcnt vmcnt(2)
v_max3_u32 v28, v20, v22, v24
v_smfmac_f32_16x16x64_bf16 v[40:43], v[20:23], a[8:15], v35
v_max_u32 v28, v28, v26
v_cmp_eq_u32 vcc, -1, v28
v_smfmac_f32_16x16x64_bf16 v[44:47], v[20:23], a[16:23], v35
s_cmp_lg_u64 vcc, 0
s_cbranch_scc1 L_k2_kernel_ar
L_k2_kernel_ao:
v_smfmac_f32_16x16x64_bf16 v[48:51], v[20:23], a[24:31], v35
v_smfmac_f32_16x16x64_bf16 v[36:39], v[24:27], a[32:39], v35
s_nop 2
v_smfmac_f32_16x16x64_bf16 v[40:43], v[24:27], a[40:47], v35
s_nop 2
v_smfmac_f32_16x16x64_bf16 v[44:47], v[24:27], a[48:55], v35
s_nop 2
v_add_f32 v92, v51, v36
v_add_f32 v92, v92, v41
s_nop 2
v_add_f32 v92, v92, v46
ds_write_b32 v3, v92
s_waitcnt lgkmcnt(0)
s_barrier
s_cmp_lg_u32 s36, 0
s_cbranch_scc1 L_k2_kernel_schk
ds_read_b32 v30, v34 offset:12
ds_read_b32 v37, v3 offset:128
ds_read2_b32 v[38:39], v3 offset0:64 offset1:96
ds_read2_b32 v[40:41], v3 offset0:128 offset1:160
ds_read2_b32 v[42:43], v3 offset0:192 offset1:224
s_mov_b32 s79, 2000
s_mov_b32 exec_hi, 0
s_waitcnt vmcnt(0)
L_k2_kernel_oc:
v_or3_b32 v28, v111, v109, v110
v_cmp_eq_u32 vcc, 0xffff, v104
v_cmp_ne_u32 s[48:49], 0, v28
s_nop 0
s_or_b64 vcc, vcc, s[48:49]
s_cbranch_scc1 L_k2_kernel_or
L_k2_kernel_oo:
v_lshlrev_b32 v100, 16, v104
s_waitcnt lgkmcnt(4)
v_readfirstlane_b32 s47, v30
s_waitcnt lgkmcnt(3)
v_add_f32 v92, v92, v37
s_cmp_lg_u32 s47, 0
s_cbranch_scc1 L_k2_kernel_gchk
s_waitcnt lgkmcnt(1)
v_pk_add_f32 v[38:39], v[38:39], v[40:41]
s_waitcnt lgkmcnt(0)
v_pk_add_f32 v[38:39], v[38:39], v[42:43]
v_add_f32 v92, v92, v38
v_add_f32 v92, v92, v39
v_cvt_pk_bf16_f32 v92, 0, v92
v_mul_f32 v92, v92, v106
v_cvt_pk_bf16_f32 v92, 0, v92
v_add_f32 v92, v92, v100
v_cvt_pk_bf16_f32 v100, v92, v92
buffer_store_short v100, v33, s[28:31], 0 offen sc1
s_endpgm
L_pf_p13:
L_pf_e1_7:
s_sub_u32 s71, s71, 1
s_cbranch_scc1 L_pf_ret
s_branch L_pf_p1
L_k2_kernel_kra:
s_sub_u32 s79, s79, 1
s_cbranch_scc1 L_k2_kernel_kta
s_sleep 3
buffer_load_dwordx4 v[12:15], v0, s[12:15], s85 offen sc1
buffer_load_dwordx4 v[16:19], v0, s[12:15], s85 offen offset:1024 sc1
s_waitcnt vmcnt(0)
s_branch L_k2_kernel_kca
L_k2_kernel_kta:
s_mov_b64 exec, 1
s_mov_b32 s46, 0x386000
buffer_store_dword v218, off, s[12:15], s46 sc1
s_mov_b64 exec, -1
s_waitcnt vmcnt(0)
buffer_load_dwordx4 v[12:15], v0, s[12:15], s85 offen sc1
buffer_load_dwordx4 v[16:19], v0, s[12:15], s85 offen offset:1024 sc1
s_waitcnt vmcnt(0)
v_max3_u32 v28, v12, v14, v16
v_max_u32 v28, v28, v18
v_cmp_eq_u32 vcc, -1, v28
s_nop 0
s_cmp_lg_u64 vcc, 0
s_cbranch_scc0 L_k2_kernel_kca
s_endpgm
L_k2_kernel_rra:
s_sub_u32 s79, s79, 1
s_cbranch_scc1 L_k2_kernel_roa
s_nop 7
s_branch L_k2_kernel_rpa
L_k2_kernel_krb:
s_sub_u32 s79, s79, 1
s_cbranch_scc1 L_k2_kernel_ktb
s_sleep 6
buffer_load_dwordx4 v[12:15], v0, s[12:15], s85 offen sc1
buffer_load_dwordx4 v[16:19], v0, s[12:15], s85 offen offset:1024 sc1
s_waitcnt vmcnt(0)
s_branch L_k2_kernel_kcb
L_k2_kernel_ktb:
s_mov_b64 exec, 1
s_mov_b32 s46, 0x386000
buffer_store_dword v218, off, s[12:15], s46 sc1
s_mov_b64 exec, -1
s_waitcnt vmcnt(0)
buffer_load_dwordx4 v[12:15], v0, s[12:15], s85 offen sc1
buffer_load_dwordx4 v[16:19], v0, s[12:15], s85 offen offset:1024 sc1
s_waitcnt vmcnt(0)
v_max3_u32 v28, v12, v14, v16
v_max_u32 v28, v28, v18
v_cmp_eq_u32 vcc, -1, v28
s_nop 0
s_cmp_lg_u64 vcc, 0
s_cbranch_scc0 L_k2_kernel_kcb
v_mov_b32 v10, 1
ds_write_b128 v34, v[8:11]
s_mov_b64 exec, 1
buffer_store_dword v218, off, s[12:15], s84 offset:3584 sc1
s_mov_b64 exec, -1
s_waitcnt vmcnt(0) lgkmcnt(0)
s_barrier
s_endpgm
L_k2_kernel_ar:
s_sub_u32 s79, s79, 1
s_nop 3
s_cbranch_scc0 L_k2_kernel_ap
v_mov_b32 v28, 1
ds_write_b32 v34, v28 offset:12
s_waitcnt lgkmcnt(0)
s_branch L_k2_kernel_ao
L_k2_kernel_or:
s_sub_u32 s79, s79, 1
s_cbranch_scc1 L_k2_kernel_oo
buffer_load_ushort v104, v7, s[12:15], s46 offen offset:896 sc1
buffer_load_dwordx4 v[108:111], v5, s[12:15], s46 offen offset:3584 sc1
s_waitcnt vmcnt(0)
s_branch L_k2_kernel_oc
L_k2_kernel_gchk:
s_waitcnt vmcnt(0) lgkmcnt(0)
s_nop 15
s_mov_b64 exec, -1
buffer_load_dwordx4 v[12:15], v0, s[12:15], s85 offen sc1
buffer_load_dwordx4 v[16:19], v0, s[12:15], s85 offen offset:1024 sc1
s_waitcnt vmcnt(0)
v_max3_u32 v28, v12, v14, v16
v_max_u32 v28, v28, v18
v_cmp_eq_u32 vcc, -1, v28
s_nop 0
s_cmp_lg_u64 vcc, 0
s_cbranch_scc1 L_k2_kernel_fin
v_min_u32 v29, v13, v15
v_med3_u32 v9, v12, v14, v29
v_min_u32 v8, v12, v14
v_min_u32 v29, v9, v17
v_med3_u32 v9, v8, v16, v29
v_min_u32 v8, v8, v16
v_min_u32 v29, v9, v19
v_med3_u32 v9, v8, v18, v29
v_min_u32 v8, v8, v18
s_nop 0
v_min_u32_dpp v29, v9, v9 quad_perm:[1,0,3,2] row_mask:0xf bank_mask:0xf
v_mov_b32_dpp v28, v8 quad_perm:[1,0,3,2] row_mask:0xf bank_mask:0xf
v_med3_u32 v9, v8, v28, v29
v_min_u32 v8, v8, v28
s_nop 0
v_min_u32_dpp v29, v9, v9 quad_perm:[2,3,0,1] row_mask:0xf bank_mask:0xf
v_mov_b32_dpp v28, v8 quad_perm:[2,3,0,1] row_mask:0xf bank_mask:0xf
v_med3_u32 v9, v8, v28, v29
v_min_u32 v8, v8, v28
s_nop 0
v_min_u32_dpp v29, v9, v9 row_half_mirror row_mask:0xf bank_mask:0xf
v_mov_b32_dpp v28, v8 row_half_mirror row_mask:0xf bank_mask:0xf
v_med3_u32 v9, v8, v28, v29
v_min_u32 v8, v8, v28
s_nop 0
v_min_u32_dpp v29, v9, v9 row_mirror row_mask:0xf bank_mask:0xf
v_mov_b32_dpp v28, v8 row_mirror row_mask:0xf bank_mask:0xf
v_med3_u32 v9, v8, v28, v29
v_min_u32 v8, v8, v28
v_mov_b32 v29, v9
v_mov_b32 v28, v8
s_nop 0
v_permlane16_swap_b32 v9, v29
v_permlane16_swap_b32 v8, v28
v_min_u32 v29, v9, v29
v_med3_u32 v9, v8, v28, v29
v_min_u32 v8, v8, v28
v_mov_b32 v29, v9
v_mov_b32 v28, v8
s_nop 0
v_permlane32_swap_b32 v9, v29
v_permlane32_swap_b32 v8, v28
v_min_u32 v29, v9, v29
v_med3_u32 v9, v8, v28, v29
v_min_u32 v8, v8, v28
s_nop 0
v_readfirstlane_b32 s80, v8
v_readfirstlane_b32 s81, v9
s_and_b32 s82, s80, 0xff0
s_lshl_b32 s82, s82, 8
s_and_b32 s46, s80, 8
s_mul_i32 s46, s46, 224
s_add_u32 s46, s46, 0x270000
s_add_u32 s82, s82, s46
s_and_b32 s83, s81, 0xff0
s_lshl_b32 s83, s83, 8
s_and_b32 s46, s81, 8
s_mul_i32 s46, s46, 224
s_add_u32 s46, s46, 0x270000
s_add_u32 s83, s83, s46
s_mov_b32 s79, 2000
L_k2_kernel_rpg:
buffer_load_dwordx4 v[20:23], v0, s[12:15], s82 offen sc1
buffer_load_dwordx4 v[24:27], v0, s[12:15], s83 offen sc1
s_waitcnt vmcnt(0)
v_max3_u32 v28, v20, v22, v24
v_max_u32 v28, v28, v26
v_cmp_eq_u32 vcc, -1, v28
s_nop 0
s_cmp_lg_u64 vcc, 0
s_cbranch_scc1 L_k2_kernel_rrg
L_k2_kernel_rog:
v_lshlrev_b32 v28, 6, v1
v_add_u32 v28, 29696, v28
s_mov_b32 exec_hi, 0x00ffffff
v_lshlrev_b32 v29, 16, v20
v_and_b32 v30, 0xffff0000, v20
ds_write_b32 v28, v29 offset:0
ds_write_b32 v28, v30 offset:8
v_lshlrev_b32 v29, 16, v21
v_and_b32 v30, 0xffff0000, v21
ds_write_b32 v28, v29 offset:16
ds_write_b32 v28, v30 offset:24
v_lshlrev_b32 v29, 16, v22
v_and_b32 v30, 0xffff0000, v22
ds_write_b32 v28, v29 offset:32
ds_write_b32 v28, v30 offset:40
v_lshlrev_b32 v29, 16, v23
v_and_b32 v30, 0xffff0000, v23
ds_write_b32 v28, v29 offset:48
ds_write_b32 v28, v30 offset:56
v_lshlrev_b32 v29, 16, v24
v_and_b32 v30, 0xffff0000, v24
ds_write_b32 v28, v29 offset:4
ds_write_b32 v28, v30 offset:12
v_lshlrev_b32 v29, 16, v25
v_and_b32 v30, 0xffff0000, v25
ds_write_b32 v28, v29 offset:20
ds_write_b32 v28, v30 offset:28
v_lshlrev_b32 v29, 16, v26
v_and_b32 v30, 0xffff0000, v26
ds_write_b32 v28, v29 offset:36
ds_write_b32 v28, v30 offset:44
v_lshlrev_b32 v29, 16, v27
v_and_b32 v30, 0xffff0000, v27
ds_write_b32 v28, v29 offset:52
ds_write_b32 v28, v30 offset:60
s_mov_b32 exec_hi, -1
s_mov_b32 s68, s62
s_mov_b32 s69, s63
s_mov_b32 s20, s64
s_mov_b32 s21, s65
s_mov_b32 s22, 1605632
s_mov_b32 s23, 0x20000
v_lshlrev_b32 v34, 2, v1
v_lshlrev_b32 v36, 4, v1
v_add_u32 v36, 33280, v36
s_mov_b32 s47, 0
s_waitcnt lgkmcnt(0)
s_nop 15
L_k2_kernel_gp1:
s_mov_b32 s48, s47
v_mov_b32 v80, 0
v_mov_b32 v81, 0
v_mov_b32 v82, 0
v_mov_b32 v83, 0
v_mov_b32 v84, 0
v_mov_b32 v85, 0
v_mov_b32 v86, 0
v_mov_b32 v87, 0
v_mov_b32 v35, 29696
s_mov_b32 s49, 112
s_nop 15
L_k2_kernel_g1:
buffer_load_dword v40, v34, s[68:71], s48 offen
buffer_load_dword v44, v34, s[20:23], s48 offen
s_add_u32 s48, s48, 3584
ds_read_b64 v[56:57], v35 offset:0
buffer_load_dword v41, v34, s[68:71], s48 offen
buffer_load_dword v45, v34, s[20:23], s48 offen
s_add_u32 s48, s48, 3584
ds_read_b64 v[58:59], v35 offset:8
buffer_load_dword v42, v34, s[68:71], s48 offen
buffer_load_dword v46, v34, s[20:23], s48 offen
s_add_u32 s48, s48, 3584
ds_read_b64 v[60:61], v35 offset:16
buffer_load_dword v43, v34, s[68:71], s48 offen
buffer_load_dword v47, v34, s[20:23], s48 offen
s_add_u32 s48, s48, 3584
ds_read_b64 v[62:63], v35 offset:24
s_waitcnt vmcnt(7)
v_lshlrev_b32 v72, 16, v40
v_and_b32 v73, 0xffff0000, v40
s_waitcnt lgkmcnt(3)
v_fmac_f32 v80, v72, v56
v_fmac_f32 v81, v72, v57
v_fmac_f32 v82, v73, v56
v_fmac_f32 v83, v73, v57
s_waitcnt vmcnt(6)
v_lshlrev_b32 v72, 16, v44
v_and_b32 v73, 0xffff0000, v44
v_fmac_f32 v84, v72, v56
v_fmac_f32 v85, v72, v57
v_fmac_f32 v86, v73, v56
v_fmac_f32 v87, v73, v57
s_waitcnt vmcnt(5)
v_lshlrev_b32 v72, 16, v41
v_and_b32 v73, 0xffff0000, v41
s_waitcnt lgkmcnt(2)
v_fmac_f32 v80, v72, v58
v_fmac_f32 v81, v72, v59
v_fmac_f32 v82, v73, v58
v_fmac_f32 v83, v73, v59
s_waitcnt vmcnt(4)
v_lshlrev_b32 v72, 16, v45
v_and_b32 v73, 0xffff0000, v45
v_fmac_f32 v84, v72, v58
v_fmac_f32 v85, v72, v59
v_fmac_f32 v86, v73, v58
v_fmac_f32 v87, v73, v59
s_waitcnt vmcnt(3)
v_lshlrev_b32 v72, 16, v42
v_and_b32 v73, 0xffff0000, v42
s_waitcnt lgkmcnt(1)
v_fmac_f32 v80, v72, v60
v_fmac_f32 v81, v72, v61
v_fmac_f32 v82, v73, v60
v_fmac_f32 v83, v73, v61
s_waitcnt vmcnt(2)
v_lshlrev_b32 v72, 16, v46
v_and_b32 v73, 0xffff0000, v46
v_fmac_f32 v84, v72, v60
v_fmac_f32 v85, v72, v61
v_fmac_f32 v86, v73, v60
v_fmac_f32 v87, v73, v61
s_waitcnt vmcnt(1)
v_lshlrev_b32 v72, 16, v43
v_and_b32 v73, 0xffff0000, v43
s_waitcnt lgkmcnt(0)
v_fmac_f32 v80, v72, v62
v_fmac_f32 v81, v72, v63
v_fmac_f32 v82, v73, v62
v_fmac_f32 v83, v73, v63
s_waitcnt vmcnt(0)
v_lshlrev_b32 v72, 16, v47
v_and_b32 v73, 0xffff0000, v47
v_fmac_f32 v84, v72, v62
v_fmac_f32 v85, v72, v63
v_fmac_f32 v86, v73, v62
v_fmac_f32 v87, v73, v63
v_add_u32 v35, 32, v35
s_sub_u32 s49, s49, 1
s_cmp_lg_u32 s49, 0
s_nop 15
s_cbranch_scc1 L_k2_kernel_g1
v_cvt_pk_bf16_f32 v80, 0, v80
v_cvt_pk_bf16_f32 v81, 0, v81
v_cvt_pk_bf16_f32 v82, 0, v82
v_cvt_pk_bf16_f32 v83, 0, v83
v_mul_f32 v100, 0xbfb8aa3b, v80
v_mul_f32 v101, 0xbfb8aa3b, v81
v_mul_f32 v102, 0xbfb8aa3b, v82
v_mul_f32 v103, 0xbfb8aa3b, v83
v_exp_f32 v100, v100
v_exp_f32 v101, v101
v_exp_f32 v102, v102
v_exp_f32 v103, v103
v_cvt_pk_bf16_f32 v84, 0, v84
v_cvt_pk_bf16_f32 v85, 0, v85
v_cvt_pk_bf16_f32 v86, 0, v86
v_cvt_pk_bf16_f32 v87, 0, v87
v_add_f32 v100, 1.0, v100
v_add_f32 v101, 1.0, v101
v_add_f32 v102, 1.0, v102
v_add_f32 v103, 1.0, v103
v_rcp_f32 v100, v100
v_rcp_f32 v101, v101
v_rcp_f32 v102, v102
v_rcp_f32 v103, v103
v_mul_f32 v80, v80, v100
v_mul_f32 v81, v81, v101
v_mul_f32 v82, v82, v102
v_mul_f32 v83, v83, v103
v_cvt_pk_bf16_f32 v80, 0, v80
v_cvt_pk_bf16_f32 v81, 0, v81
v_cvt_pk_bf16_f32 v82, 0, v82
v_cvt_pk_bf16_f32 v83, 0, v83
v_mul_f32 v80, v80, v84
v_mul_f32 v81, v81, v85
v_mul_f32 v82, v82, v86
v_mul_f32 v83, v83, v87
v_cvt_pk_bf16_f32 v80, 0, v80
v_cvt_pk_bf16_f32 v81, 0, v81
v_cvt_pk_bf16_f32 v82, 0, v82
v_cvt_pk_bf16_f32 v83, 0, v83
ds_write_b128 v36, v[80:83]
v_add_u32 v36, 1024, v36
s_add_u32 s47, s47, 256
s_cmp_lt_u32 s47, 3584
s_waitcnt lgkmcnt(0)
s_nop 15
s_cbranch_scc1 L_k2_kernel_gp1
s_mov_b32 s68, s66
s_mov_b32 s69, s67
v_mov_b32 v37, s80
v_mov_b32 v38, s81
v_and_b32 v37, 0xffffe000, v37
v_ashrrev_i32 v28, 31, v37
v_not_b32 v28, v28
v_or_b32 v28, 0x80000000, v28
v_xor_b32 v37, v37, v28
v_cvt_pk_bf16_f32 v37, 0, v37
v_mul_f32 v37, 0x3fb8aa3b, v37
v_exp_f32 v37, v37
s_nop 0
v_add_f32 v37, 1.0, v37
v_rcp_f32 v37, v37
s_nop 0
v_cvt_pk_bf16_f32 v37, 0, v37
v_and_b32 v38, 0xffffe000, v38
v_ashrrev_i32 v28, 31, v38
v_not_b32 v28, v28
v_or_b32 v28, 0x80000000, v28
v_xor_b32 v38, v38, v28
v_cvt_pk_bf16_f32 v38, 0, v38
v_mul_f32 v38, 0x3fb8aa3b, v38
v_exp_f32 v38, v38
s_nop 0
v_add_f32 v38, 1.0, v38
v_rcp_f32 v38, v38
s_nop 0
v_cvt_pk_bf16_f32 v38, 0, v38
s_and_b32 s46, s80, 0xff0
s_lshr_b32 s46, s46, 1
s_and_b32 s80, s80, 7
s_add_u32 s80, s80, s46
s_mul_i32 s80, s80, 896
s_and_b32 s46, s81, 0xff0
s_lshr_b32 s46, s46, 1
s_and_b32 s81, s81, 7
s_add_u32 s81, s81, s46
s_mul_i32 s81, s81, 896
s_mov_b32 s79, 2000
s_and_b32 s48, s82, 0xfffff000
s_and_b32 s49, s83, 0xfffff000
s_nop 15
L_k2_kernel_gd:
buffer_load_dwordx4 v[20:23], off, s[12:15], s48 offset:3584 sc1
buffer_load_dwordx4 v[24:27], off, s[12:15], s49 offset:3584 sc1
s_waitcnt vmcnt(1)
v_or3_b32 v28, v23, v21, v22
s_waitcnt vmcnt(0)
v_or3_b32 v28, v28, v25, v26
v_or_b32 v28, v28, v27
s_nop 0
v_readfirstlane_b32 s46, v28
s_sub_u32 s79, s79, 1
s_cselect_b32 s46, 0, s46
s_cmp_lg_u32 s46, 0
s_nop 15
s_cbranch_scc1 L_k2_kernel_gd
s_mov_b32 s47, 0
L_k2_kernel_gp2:
s_mov_b32 s48, s47
v_mov_b32 v80, 0
v_mov_b32 v81, 0
v_mov_b32 v82, 0
v_mov_b32 v83, 0
v_mov_b32 v35, 33280
s_mov_b32 s49, 448
s_nop 15
L_k2_kernel_g2:
buffer_load_dword v40, v34, s[68:71], s48 offen
s_add_u32 s48, s48, 896
ds_read_b64 v[56:57], v35 offset:0
buffer_load_dword v41, v34, s[68:71], s48 offen
s_add_u32 s48, s48, 896
ds_read_b64 v[58:59], v35 offset:8
buffer_load_dword v42, v34, s[68:71], s48 offen
s_add_u32 s48, s48, 896
ds_read_b64 v[60:61], v35 offset:16
buffer_load_dword v43, v34, s[68:71], s48 offen
s_add_u32 s48, s48, 896
ds_read_b64 v[62:63], v35 offset:24
s_waitcnt vmcnt(3)
v_lshlrev_b32 v72, 16, v40
v_and_b32 v73, 0xffff0000, v40
s_waitcnt lgkmcnt(3)
v_fmac_f32 v80, v72, v56
v_fmac_f32 v81, v72, v57
v_fmac_f32 v82, v73, v56
v_fmac_f32 v83, v73, v57
s_waitcnt vmcnt(2)
v_lshlrev_b32 v72, 16, v41
v_and_b32 v73, 0xffff0000, v41
s_waitcnt lgkmcnt(2)
v_fmac_f32 v80, v72, v58
v_fmac_f32 v81, v72, v59
v_fmac_f32 v82, v73, v58
v_fmac_f32 v83, v73, v59
s_waitcnt vmcnt(1)
v_lshlrev_b32 v72, 16, v42
v_and_b32 v73, 0xffff0000, v42
s_waitcnt lgkmcnt(1)
v_fmac_f32 v80, v72, v60
v_fmac_f32 v81, v72, v61
v_fmac_f32 v82, v73, v60
v_fmac_f32 v83, v73, v61
s_waitcnt vmcnt(0)
v_lshlrev_b32 v72, 16, v43
v_and_b32 v73, 0xffff0000, v43
s_waitcnt lgkmcnt(0)
v_fmac_f32 v80, v72, v62
v_fmac_f32 v81, v72, v63
v_fmac_f32 v82, v73, v62
v_fmac_f32 v83, v73, v63
v_add_u32 v35, 32, v35
s_sub_u32 s49, s49, 1
s_cmp_lg_u32 s49, 0
s_nop 15
s_cbranch_scc1 L_k2_kernel_g2
v_add_u32 v28, s47, v34
buffer_load_dword v40, v28, s[12:15], s82 offen offset:896 sc1
buffer_load_dword v41, v28, s[12:15], s83 offen offset:896 sc1
v_cvt_pk_bf16_f32 v80, 0, v80
v_mul_f32 v80, v80, v37
v_cvt_pk_bf16_f32 v80, 0, v80
v_cvt_pk_bf16_f32 v81, 0, v81
v_mul_f32 v81, v81, v38
v_cvt_pk_bf16_f32 v81, 0, v81
v_cvt_pk_bf16_f32 v82, 0, v82
v_mul_f32 v82, v82, v37
v_cvt_pk_bf16_f32 v82, 0, v82
v_cvt_pk_bf16_f32 v83, 0, v83
v_mul_f32 v83, v83, v38
v_cvt_pk_bf16_f32 v83, 0, v83
v_cmp_gt_u32 vcc, 0x380, v28
s_waitcnt vmcnt(1)
v_lshlrev_b32 v72, 16, v40
v_and_b32 v73, 0xffff0000, v40
v_add_f32 v80, v80, v72
v_add_f32 v82, v82, v73
v_cvt_pk_bf16_f32 v74, v80, v82
s_waitcnt vmcnt(0)
v_lshlrev_b32 v72, 16, v41
v_and_b32 v73, 0xffff0000, v41
v_add_f32 v81, v81, v72
v_add_f32 v83, v83, v73
v_cvt_pk_bf16_f32 v75, v81, v83
s_mov_b64 exec, vcc
buffer_store_dword v74, v28, s[28:31], s80 offen sc1
buffer_store_dword v75, v28, s[28:31], s81 offen sc1
s_mov_b64 exec, -1
s_add_u32 s47, s47, 256
s_cmp_lt_u32 s47, 896
s_waitcnt vmcnt(0)
s_nop 15
s_cbranch_scc1 L_k2_kernel_gp2
s_endpgm
L_k2_kernel_rrg:
s_sub_u32 s79, s79, 1
s_cbranch_scc1 L_k2_kernel_rog
s_branch L_k2_kernel_rpg
L_k2_kernel_fallback:
s_cmp_lg_u32 s45, 0
s_cbranch_scc1 L_k2_kernel_fbno
s_waitcnt vmcnt(0) lgkmcnt(0)
s_nop 15
v_mov_b32 v3, 0
v_accvgpr_write_b32 a54, v3
v_accvgpr_write_b32 a55, v3
v_accvgpr_write_b32 a62, v3
v_accvgpr_write_b32 a63, v3
v_accvgpr_write_b32 a70, v3
v_accvgpr_write_b32 a71, v3
v_accvgpr_write_b32 a78, v3
v_accvgpr_write_b32 a79, v3
v_mul_u32_u24 v48, 37, v1
v_lshrrev_b32 v48, 9, v48
v_mul_i32_i24 v48, -1776, v48
v_lshl_add_u32 v48, v1, 7, v48
s_mov_b32 m0, s42
s_mov_b32 exec_hi, 0x00ffffff
buffer_load_dwordx4 v48, s[12:15], s41 offen lds
s_add_u32 m0, s42, 832
s_nop 0
buffer_load_dwordx4 v48, s[12:15], s41 offen offset:64 lds
s_mov_b32 exec_hi, -1
v_and_b32 v4, 15, v1
v_mul_u32_u24 v4, 56, v4
v_lshrrev_b32 v5, 5, v1
v_lshl_add_u32 v7, v5, 3, v4
v_bfe_u32 v49, v1, 4, 1
v_mul_u32_u24 v49, 224, v49
v_bfe_u32 v50, v1, 2, 2
v_mul_u32_u24 v50, 1760, v50
v_add3_u32 v49, v49, v50, v7
s_add_u32 s46, s36, 0
s_and_b32 s46, s46, 3
s_mul_i32 s46, s46, 448
s_add_u32 s46, s46, 8192
v_add_u32 v44, s46, v49
s_add_u32 s46, s36, 1
s_and_b32 s46, s46, 3
s_mul_i32 s46, s46, 448
s_add_u32 s46, s46, 8192
v_add_u32 v45, s46, v49
s_add_u32 s46, s36, 2
s_and_b32 s46, s46, 3
s_mul_i32 s46, s46, 448
s_add_u32 s46, s46, 8192
v_add_u32 v46, s46, v49
s_add_u32 s46, s36, 3
s_and_b32 s46, s46, 3
s_mul_i32 s46, s46, 448
s_add_u32 s46, s46, 8192
v_add_u32 v47, s46, v49
s_waitcnt vmcnt(0)
s_barrier
ds_read_b64 a[56:57], v45 offset:0
ds_read_b64 a[58:59], v45 offset:16
ds_read_b64 a[60:61], v45 offset:32
s_mov_b32 exec_hi, 0
ds_read_b64 a[62:63], v45 offset:48
s_mov_b32 exec_hi, -1
ds_read_b64 a[64:65], v46 offset:0
ds_read_b64 a[66:67], v46 offset:16
ds_read_b64 a[68:69], v46 offset:32
s_mov_b32 exec_hi, 0
ds_read_b64 a[70:71], v46 offset:48
s_mov_b32 exec_hi, -1
ds_read_b64 a[72:73], v47 offset:0
ds_read_b64 a[74:75], v47 offset:16
ds_read_b64 a[76:77], v47 offset:32
s_mov_b32 exec_hi, 0
ds_read_b64 a[78:79], v47 offset:48
s_mov_b32 exec_hi, -1
ds_read_b64 a[48:49], v44 offset:0
ds_read_b64 a[50:51], v44 offset:16
ds_read_b64 a[52:53], v44 offset:32
s_mov_b32 exec_hi, 0
ds_read_b64 a[54:55], v44 offset:48
s_mov_b32 exec_hi, -1
s_waitcnt lgkmcnt(0)
s_nop 15
v_mov_b32 v44, 0xff800000
v_mov_b32 v45, 0xff800000
v_mov_b32 v46, 0xff800000
v_mov_b32 v47, 0xff800000
s_mov_b32 s39, 0
s_nop 15
L_k2_kernel_fbloop:
buffer_load_dwordx4 v[52:55], v0, s[16:19], s39 offen offset:0
buffer_load_dwordx4 v[56:59], v0, s[16:19], s39 offen offset:1024
s_waitcnt vmcnt(1)
v_mfma_f32_32x32x16_bf16 v[12:27], v[52:55], a[48:51], 0
s_waitcnt vmcnt(0)
v_mfma_f32_32x32x16_bf16 v[12:27], v[56:59], a[52:55], v[12:27]
s_nop 11
v_max3_f32 v44, v44, v12, v13
v_max3_f32 v44, v44, v14, v15
v_max3_f32 v44, v44, v16, v17
v_max3_f32 v44, v44, v18, v19
v_max3_f32 v44, v44, v20, v21
v_max3_f32 v44, v44, v22, v23
v_max3_f32 v44, v44, v24, v25
v_max3_f32 v44, v44, v26, v27
v_mfma_f32_32x32x16_bf16 v[28:43], v[52:55], a[56:59], 0
v_mfma_f32_32x32x16_bf16 v[28:43], v[56:59], a[60:63], v[28:43]
s_nop 11
v_max3_f32 v45, v45, v28, v29
v_max3_f32 v45, v45, v30, v31
v_max3_f32 v45, v45, v32, v33
v_max3_f32 v45, v45, v34, v35
v_max3_f32 v45, v45, v36, v37
v_max3_f32 v45, v45, v38, v39
v_max3_f32 v45, v45, v40, v41
v_max3_f32 v45, v45, v42, v43
v_mfma_f32_32x32x16_bf16 v[12:27], v[52:55], a[64:67], 0
v_mfma_f32_32x32x16_bf16 v[12:27], v[56:59], a[68:71], v[12:27]
s_nop 11
v_max3_f32 v46, v46, v12, v13
v_max3_f32 v46, v46, v14, v15
v_max3_f32 v46, v46, v16, v17
v_max3_f32 v46, v46, v18, v19
v_max3_f32 v46, v46, v20, v21
v_max3_f32 v46, v46, v22, v23
v_max3_f32 v46, v46, v24, v25
v_max3_f32 v46, v46, v26, v27
v_mfma_f32_32x32x16_bf16 v[28:43], v[52:55], a[72:75], 0
v_mfma_f32_32x32x16_bf16 v[28:43], v[56:59], a[76:79], v[28:43]
s_nop 11
v_max3_f32 v47, v47, v28, v29
v_max3_f32 v47, v47, v30, v31
v_max3_f32 v47, v47, v32, v33
v_max3_f32 v47, v47, v34, v35
v_max3_f32 v47, v47, v36, v37
v_max3_f32 v47, v47, v38, v39
v_max3_f32 v47, v47, v40, v41
v_max3_f32 v47, v47, v42, v43
s_add_u32 s39, s39, 4096
s_cmp_lt_u32 s39, 65536
s_nop 15
s_cbranch_scc1 L_k2_kernel_fbloop
v_mov_b32 v48, v44
v_mov_b32 v49, v45
v_mov_b32 v50, v46
v_mov_b32 v51, v47
v_permlane32_swap_b32 v44, v48
v_permlane32_swap_b32 v45, v49
v_permlane32_swap_b32 v46, v50
v_permlane32_swap_b32 v47, v51
v_max_f32 v44, v44, v48
v_max_f32 v45, v45, v49
v_max_f32 v46, v46, v50
v_max_f32 v47, v47, v51
v_and_b32 v3, 31, v1
v_lshlrev_b32 v3, 2, v3
v_add_u32 v3, 0, v3
s_add_u32 s46, s36, 0
s_and_b32 s46, s46, 3
s_lshl_b32 s46, s46, 7
v_add_u32 v48, s46, v3
s_lshl_b32 s47, s36, 9
v_add_u32 v4, s47, v48
ds_write_b32 v4, v44
s_add_u32 s46, s36, 1
s_and_b32 s46, s46, 3
s_lshl_b32 s46, s46, 7
v_add_u32 v49, s46, v3
s_lshl_b32 s47, s36, 9
v_add_u32 v4, s47, v49
ds_write_b32 v4, v45
s_add_u32 s46, s36, 2
s_and_b32 s46, s46, 3
s_lshl_b32 s46, s46, 7
v_add_u32 v50, s46, v3
s_lshl_b32 s47, s36, 9
v_add_u32 v4, s47, v50
ds_write_b32 v4, v46
s_add_u32 s46, s36, 3
s_and_b32 s46, s46, 3
s_lshl_b32 s46, s46, 7
v_add_u32 v51, s46, v3
s_lshl_b32 s47, s36, 9
v_add_u32 v4, s47, v51
ds_write_b32 v4, v47
s_waitcnt lgkmcnt(0)
s_barrier
ds_read_b32 v12, v48 offset:0
ds_read_b32 v13, v48 offset:512
ds_read_b32 v14, v48 offset:1024
ds_read_b32 v15, v48 offset:1536
ds_read_b32 v16, v49 offset:0
ds_read_b32 v17, v49 offset:512
ds_read_b32 v18, v49 offset:1024
ds_read_b32 v19, v49 offset:1536
ds_read_b32 v20, v50 offset:0
ds_read_b32 v21, v50 offset:512
ds_read_b32 v22, v50 offset:1024
ds_read_b32 v23, v50 offset:1536
ds_read_b32 v24, v51 offset:0
ds_read_b32 v25, v51 offset:512
ds_read_b32 v26, v51 offset:1024
ds_read_b32 v27, v51 offset:1536
s_waitcnt lgkmcnt(13)
v_max3_f32 v12, v12, v13, v14
s_waitcnt lgkmcnt(12)
v_max_f32 v12, v12, v15
v_sub_f32 v12, 0, v12
v_cvt_pk_bf16_f32 v13, 0, v12
v_sub_f32 v12, v12, v13
v_cvt_pk_bf16_f32 v14, 0, v12
v_sub_f32 v12, v12, v14
v_cvt_pk_bf16_f32 v28, v13, v14
v_cvt_pk_bf16_f32 v29, v12, 0
s_waitcnt lgkmcnt(9)
v_max3_f32 v16, v16, v17, v18
s_waitcnt lgkmcnt(8)
v_max_f32 v16, v16, v19
v_sub_f32 v16, 0, v16
v_cvt_pk_bf16_f32 v17, 0, v16
v_sub_f32 v16, v16, v17
v_cvt_pk_bf16_f32 v18, 0, v16
v_sub_f32 v16, v16, v18
v_cvt_pk_bf16_f32 v30, v17, v18
v_cvt_pk_bf16_f32 v31, v16, 0
s_waitcnt lgkmcnt(5)
v_max3_f32 v20, v20, v21, v22
s_waitcnt lgkmcnt(4)
v_max_f32 v20, v20, v23
v_sub_f32 v20, 0, v20
v_cvt_pk_bf16_f32 v21, 0, v20
v_sub_f32 v20, v20, v21
v_cvt_pk_bf16_f32 v22, 0, v20
v_sub_f32 v20, v20, v22
v_cvt_pk_bf16_f32 v32, v21, v22
v_cvt_pk_bf16_f32 v33, v20, 0
s_waitcnt lgkmcnt(1)
v_max3_f32 v24, v24, v25, v26
s_waitcnt lgkmcnt(0)
v_max_f32 v24, v24, v27
v_sub_f32 v24, 0, v24
v_cvt_pk_bf16_f32 v25, 0, v24
v_sub_f32 v24, v24, v25
v_cvt_pk_bf16_f32 v26, 0, v24
v_sub_f32 v24, v24, v26
v_cvt_pk_bf16_f32 v34, v25, v26
v_cvt_pk_bf16_f32 v35, v24, 0
s_mov_b32 s45, -1
s_load_dwordx8 s[60:67], s[0:1], 48
s_load_dwordx2 s[4:5], s[0:1], 0
s_load_dwordx2 s[8:9], s[0:1], 80
v_mul_u32_u24 v48, 37, v1
v_lshrrev_b32 v48, 9, v48
v_mul_i32_i24 v48, -1776, v48
v_lshl_add_u32 v48, v1, 7, v48
v_and_b32 v4, 15, v1
v_mul_u32_u24 v4, 56, v4
v_lshrrev_b32 v5, 5, v1
v_lshl_add_u32 v7, v5, 3, v4
s_waitcnt lgkmcnt(0)
s_nop 15
s_barrier
s_branch L_k2_kernel_start
L_k2_kernel_end:
s_endpgm
.section .rodata,"a"
.p2align 6
.amdhsa_kernel k1_kernel
  .amdhsa_next_free_vgpr 168
  .amdhsa_next_free_sgpr 102
  .amdhsa_accum_offset 168
  .amdhsa_group_segment_fixed_size 0
  .amdhsa_kernarg_size 104
  .amdhsa_user_sgpr_count 2
  .amdhsa_user_sgpr_kernarg_segment_ptr 1
  .amdhsa_system_sgpr_workgroup_id_x 1
.end_amdhsa_kernel
.p2align 6
.amdhsa_kernel k2_kernel
  .amdhsa_next_free_vgpr 512
  .amdhsa_next_free_sgpr 102
  .amdhsa_accum_offset 256
  .amdhsa_group_segment_fixed_size 0
  .amdhsa_kernarg_size 104
  .amdhsa_user_sgpr_count 2
  .amdhsa_user_sgpr_kernarg_segment_ptr 1
  .amdhsa_system_sgpr_workgroup_id_x 1
.end_amdhsa_kernel
```
